```python
import torch

def _softmax(x, axis=-1):
    return torch.softmax(x, dim=axis)
def _gelu(x):
    return torch.nn.functional.gelu(x, approximate="tanh")
def _silu(x):
    return torch.nn.functional.silu(x)
def _sigmoid(x):
    return torch.sigmoid(x)
def _layernorm(x, axis=-1, eps=1e-5):
    m = x.mean(dim=axis, keepdim=True)
    v = x.var(dim=axis, keepdim=True, unbiased=False)
    return (x - m) / torch.sqrt(v + eps)
def _scatter_add(tgt, idx, src, axis=0):
    return tgt.clone().index_add_(axis, idx, src)
def _segment_sum(src, seg, n):
    out = torch.zeros((n,) + src.shape[1:], dtype=src.dtype)
    return out.index_add_(0, seg, src)
def _pad(x, pw):
    flat = tuple(v for pair in reversed(pw) for v in pair)
    return torch.nn.functional.pad(x, flat)

kernel_name = 'interleave_layers__sliding_block_cached__sliding_block_cached__decode'

def setup_inputs():

    _w = (lambda a: (lambda t: t.to(torch.bfloat16) if t.is_floating_point() else t)(torch.as_tensor(a)))
    def _A_setup():
        B, Sq, D = 8, 1, 448
        Hq, Hkv, Sk, Dh = 16, 8, 4096, 256
        assert Hq % Hkv == 0, (Hq, Hkv)
        return {
            "x": _w((lambda *s: torch.randn(*s, dtype=torch.bfloat16) * 0.1)(B, Sq, D)),
            "k_cache": _w((lambda *s: torch.randn(*s, dtype=torch.bfloat16) * 0.8)(B, Hkv, Sk, Dh)),
            "v_cache": _w((lambda *s: torch.randn(*s, dtype=torch.bfloat16) * 3.2)(B, Hkv, Sk, Dh)),
            "wq": _w((lambda *s: torch.randn(*s, dtype=torch.bfloat16) * 0.8)(D, Hq * Dh) * (D ** -0.5)),
            "wo": _w((lambda *s: torch.randn(*s, dtype=torch.bfloat16) * 3.2)(Hq * Dh, D) * ((Hq * Dh) ** -0.5)),
        }
    _A_in = _A_setup()

    def _B_setup():
        B, Sq, D = 8, 1, 448
        Hq, Hkv, Sk, Dh = 16, 8, 4096, 256
        assert Hq % Hkv == 0, (Hq, Hkv)
        return {
            "x": _w((lambda *s: torch.randn(*s, dtype=torch.bfloat16) * 0.1)(B, Sq, D)),
            "k_cache": _w((lambda *s: torch.randn(*s, dtype=torch.bfloat16) * 0.8)(B, Hkv, Sk, Dh)),
            "v_cache": _w((lambda *s: torch.randn(*s, dtype=torch.bfloat16) * 1.6)(B, Hkv, Sk, Dh)),
            "wq": _w((lambda *s: torch.randn(*s, dtype=torch.bfloat16) * 0.8)(D, Hq * Dh) * (D ** -0.5)),
            "wo": _w((lambda *s: torch.randn(*s, dtype=torch.bfloat16) * 1.6)(Hq * Dh, D) * ((Hq * Dh) ** -0.5)),
        }
    _B_in = _B_setup()

    return {
        "A_x": _A_in["x"],
        "A_k_cache": _A_in["k_cache"],
        "A_v_cache": _A_in["v_cache"],
        "A_wq": _A_in["wq"],
        "A_wo": _A_in["wo"],
        "B_x": _B_in["x"],
        "B_k_cache": _B_in["k_cache"],
        "B_v_cache": _B_in["v_cache"],
        "B_wq": _B_in["wq"],
        "B_wo": _B_in["wo"],
    }

def reference(A_x, A_k_cache, A_v_cache, A_wq, A_wo, B_x, B_k_cache, B_v_cache, B_wq, B_wo):
    def _A_ref(x, k_cache, v_cache, wq, wo):
        B, Sq, D = x.shape
        Hq, Dh = 16, 256
        Hkv, Sk = k_cache.shape[1], k_cache.shape[2]
        W = min(4096, max(256, Sk // 4))
        rep = Hq // Hkv
        q = (lambda x, *d: x.permute(*d))((x @ wq).reshape(B, Sq, Hq, Dh), 0, 2, 1, 3)
        k = (lambda x, n, axis: torch.repeat_interleave(x, n, dim=axis))(k_cache[:, :, Sk - W:, :], rep, axis=1)
        v = (lambda x, n, axis: torch.repeat_interleave(x, n, dim=axis))(v_cache[:, :, Sk - W:, :], rep, axis=1)
        scores = torch.einsum("bhqd,bhkd->bhqk", q, k) * (Dh ** -0.5)
        p = _softmax(scores, axis=-1)
        o = torch.einsum("bhqk,bhkd->bhqd", p, v)
        return (lambda x, *d: x.permute(*d))(o, 0, 2, 1, 3).reshape(B, Sq, Hq * Dh) @ wo

    def _B_ref(x, k_cache, v_cache, wq, wo):
        B, Sq, D = x.shape
        Hq, Dh = 16, 256
        Hkv, Sk = k_cache.shape[1], k_cache.shape[2]
        W = min(4096, max(256, Sk // 4))
        rep = Hq // Hkv
        q = (lambda x, *d: x.permute(*d))((x @ wq).reshape(B, Sq, Hq, Dh), 0, 2, 1, 3)
        k = (lambda x, n, axis: torch.repeat_interleave(x, n, dim=axis))(k_cache[:, :, Sk - W:, :], rep, axis=1)
        v = (lambda x, n, axis: torch.repeat_interleave(x, n, dim=axis))(v_cache[:, :, Sk - W:, :], rep, axis=1)
        scores = torch.einsum("bhqd,bhkd->bhqk", q, k) * (Dh ** -0.5)
        p = _softmax(scores, axis=-1)
        o = torch.einsum("bhqk,bhkd->bhqd", p, v)
        return (lambda x, *d: x.permute(*d))(o, 0, 2, 1, 3).reshape(B, Sq, Hq * Dh) @ wo

    x = A_x
    x = x + _A_ref(_layernorm(x, axis=-1), A_k_cache, A_v_cache, A_wq, A_wo)
    x = x + _B_ref(_layernorm(x, axis=-1), B_k_cache, B_v_cache, B_wq, B_wo)
    x = x + _A_ref(_layernorm(x, axis=-1), A_k_cache, A_v_cache, A_wq, A_wo)
    x = x + _B_ref(_layernorm(x, axis=-1), B_k_cache, B_v_cache, B_wq, B_wo)
    return x
```

```asm
; @launch grid=(256,1,1) block=(256,1,1) lds=163840
.amdgcn_target "amdgcn-amd-amdhsa--gfx950"
.text
.globl interleave_layers__sliding_block_cached__sliding_block_cached__decode_kernel
.p2align 8
.type interleave_layers__sliding_block_cached__sliding_block_cached__decode_kernel,@function
interleave_layers__sliding_block_cached__sliding_block_cached__decode_kernel:
    s_cmp_ge_u32 s2, 256
    s_cbranch_scc1 L_end
    s_load_dwordx16 s[8:23], s[0:1], 0
    s_load_dwordx8 s[24:31], s[0:1], 64
    s_load_dwordx2 s[32:33], s[0:1], 96
    v_lshrrev_b32 v1, 6, v0
    v_and_b32 v0, 63, v0
    v_readfirstlane_b32 s3, v1
    s_and_b32 s4, s2, 7
    s_lshr_b32 s5, s2, 3
    s_lshr_b32 s6, s2, 5
    s_and_b32 s7, s5, 3
    s_lshl_b32 s62, s3, 15
    s_lshl_b32 s63, s3, 10
    s_add_u32 s63, s63, 159744
    s_mov_b32 s64, 0
    s_mov_b32 s65, 65536
    s_mov_b32 s66, 131072
    s_mov_b32 s67, 196608
    s_mov_b32 s68, 262144
    s_mov_b32 s69, 327680
    s_mov_b32 s70, 393216
    s_mov_b32 s71, 458752
    s_lshl_b32 s72, s7, 14
    s_lshl_b32 s73, s3, 12
    s_add_u32 s73, s72, s73
    v_lshrrev_b32 v20, 5, v0
    v_and_b32 v21, 31, v0
    v_xor_b32 v21, v21, v20
    v_lshlrev_b32 v20, 9, v20
    v_lshl_add_u32 v20, v21, 4, v20
    v_add_u32 v1, s73, v20
    s_lshl_b32 s72, s6, 3
    s_add_u32 s72, s72, s4
    s_lshl_b32 s72, s72, 21
    s_add_u32 s72, s72, 0x180000
    s_waitcnt lgkmcnt(0)
    s_add_u32 s36, s10, s72
    s_addc_u32 s37, s11, 0
    s_mov_b32 s38, 0x80000
    s_mov_b32 s39, 0x20000
    s_add_u32 s40, s12, s72
    s_addc_u32 s41, s13, 0
    s_mov_b32 s42, 0x80000
    s_mov_b32 s43, 0x20000
    s_add_u32 s44, s20, s72
    s_addc_u32 s45, s21, 0
    s_mov_b32 s46, 0x80000
    s_mov_b32 s47, 0x20000
    s_add_u32 s48, s22, s72
    s_addc_u32 s49, s23, 0
    s_mov_b32 s50, 0x80000
    s_mov_b32 s51, 0x20000
    s_add_u32 m0, s62, 0
    s_nop 0
    buffer_load_dwordx4 v1, s[36:39], s64 offen offset:0 nt lds
    v_xor_b32 v63, 32, v1
    buffer_load_dwordx4 v63, s[36:39], s64 offen offset:1024 nt lds
    v_xor_b32 v63, 64, v1
    buffer_load_dwordx4 v63, s[36:39], s64 offen offset:2048 nt lds
    v_xor_b32 v63, 96, v1
    buffer_load_dwordx4 v63, s[36:39], s64 offen offset:3072 nt lds
    s_add_u32 m0, s62, 4096
    v_xor_b32 v63, 128, v1
    buffer_load_dwordx4 v63, s[36:39], s65 offen offset:0 nt lds
    v_xor_b32 v63, 160, v1
    buffer_load_dwordx4 v63, s[36:39], s65 offen offset:1024 nt lds
    v_xor_b32 v63, 192, v1
    buffer_load_dwordx4 v63, s[36:39], s65 offen offset:2048 nt lds
    v_xor_b32 v63, 224, v1
    buffer_load_dwordx4 v63, s[36:39], s65 offen offset:3072 nt lds
    s_mov_b32 s52, s32
    s_mov_b32 s53, s33
    s_mov_b32 s54, 0
    s_mov_b32 s55, 0x20000
    s_mov_b32 s20, s32
    s_mov_b32 s21, s33
    s_mov_b32 s22, 0
    s_mov_b32 s23, 0x20000
    s_mov_b32 s92, s32
    s_mov_b32 s93, s33
    s_mov_b32 s94, 0
    s_mov_b32 s95, 0x20000
    s_mov_b32 s74, 1000000
    s_mov_b32 s75, 0
    s_mov_b32 s96, 1035512379
    s_mov_b32 s100, 1
    s_mov_b32 s101, 0x3f80
    s_mov_b32 s10, -1
    s_mov_b32 s11, 0
    s_mov_b32 s88, 0xff
    s_mov_b32 s89, 0xff
    s_mov_b32 s86, 0x00f0000f
    s_mov_b32 s87, 0xf0000f00
    s_mov_b32 s12, s5
    s_lshr_b32 s72, s5, 1
    s_add_i32 s73, s5, 22
    s_cmp_eq_u32 s72, 3
    s_cselect_b32 s12, s73, s12
    s_add_i32 s73, s5, -22
    s_cmp_eq_u32 s72, 14
    s_cselect_b32 s12, s73, s12
    s_add_i32 s73, s5, 8
    s_cmp_eq_u32 s72, 11
    s_cselect_b32 s12, s73, s12
    s_add_i32 s73, s5, -8
    s_cmp_eq_u32 s72, 15
    s_cselect_b32 s12, s73, s12
    s_and_b32 s18, s12, 15
    s_lshl_b32 s18, s18, 1
    s_add_u32 s18, s18, s3
    s_lshr_b32 s19, s12, 4
    s_cmp_ge_u32 s3, 2
    s_cselect_b32 s19, 2, s19
    v_and_b32 v48, 15, v0
    v_lshrrev_b32 v49, 4, v0
    v_bfe_u32 v50, v0, 2, 2
    v_and_b32 v51, 3, v0
    v_and_b32 v52, 1, v0
    v_lshlrev_b32 v20, 4, v0
    v_add_u32 v6, s63, v20
    v_bfe_u32 v20, v0, 2, 1
    v_mul_u32_u24 v20, 896, v20
    v_lshl_add_u32 v20, v51, 3, v20
    v_lshrrev_b32 v21, 5, v0
    v_lshl_add_u32 v14, v21, 2, v20
    v_bfe_u32 v20, v0, 1, 1
    v_lshlrev_b32 v20, 8, v20
    v_lshl_add_u32 v20, v21, 2, v20
    v_bfe_u32 v21, v0, 2, 1
    v_lshl_add_u32 v20, v21, 4, v20
    v_lshl_add_u32 v13, v52, 3, v20
    v_lshrrev_b32 v20, 1, v49
    v_lshlrev_b32 v20, 11, v20
    v_and_b32 v21, 1, v49
    v_lshl_add_u32 v20, v21, 6, v20
    v_lshl_add_u32 v12, v48, 2, v20
    s_lshl_b32 s72, s7, 14
    s_lshl_b32 s73, s3, 7
    s_add_u32 s72, s72, s73
    v_and_b32 v20, 7, v0
    v_lshlrev_b32 v21, 1, v21
    v_xor_b32 v20, v20, v21
    v_lshrrev_b32 v21, 3, v0
    v_lshlrev_b32 v21, 9, v21
    v_lshl_add_u32 v20, v20, 4, v21
    v_add_u32 v2, s72, v20
    v_xor_b32 v3, 64, v2
    v_bfe_u32 v20, v0, 3, 1
    v_lshlrev_b32 v20, 12, v20
    v_and_b32 v21, 7, v0
    v_lshl_add_u32 v20, v21, 9, v20
    v_xor_b32 v21, v49, v48
    v_lshl_add_u32 v20, v21, 4, v20
    v_add_u32 v4, s62, v20
    v_and_b32 v21, 1, v49
    v_mul_u32_u24 v20, 4160, v21
    v_lshrrev_b32 v21, 1, v49
    v_lshl_add_u32 v20, v21, 10, v20
    v_lshl_add_u32 v20, v50, 7, v20
    v_lshl_add_u32 v20, v51, 3, v20
    v_lshrrev_b32 v21, 1, v50
    v_lshl_add_u32 v20, v21, 5, v20
    v_add_u32 v5, s62, v20
    v_bfe_u32 v22, v0, 1, 1
    v_mul_u32_u24 v17, 0xaaaa, v22
    v_add_u32 v17, 0x4444, v17
    v_lshlrev_b32 v20, 9, v52
    v_lshl_add_u32 v20, v49, 5, v20
    v_lshl_add_u32 v20, v22, 4, v20
    v_add_u32 v7, s63, v20
    v_lshlrev_b32 v20, 7, v52
    v_lshl_add_u32 v20, v49, 10, v20
    v_lshl_add_u32 v20, v22, 4, v20
    v_add_u32 v9, 159744, v20
    v_lshlrev_b32 v20, 5, v49
    v_lshl_add_u32 v20, v22, 4, v20
    v_lshl_add_u32 v20, v50, 2, v20
    v_lshl_add_u32 v20, v52, 1, v20
    v_add_u32 v8, s63, v20
    v_and_b32 v20, 2, v0
    v_lshlrev_b32 v20, 1, v20
    v_lshl_add_u32 v20, v52, 14, v20
    v_lshrrev_b32 v21, 5, v0
    v_lshl_add_u32 v20, v21, 10, v20
    v_lshl_add_u32 v20, v50, 8, v20
    v_and_b32 v22, 1, v49
    v_lshl_add_u32 v10, v22, 3, v20
    v_and_b32 v20, 31, v0
    v_lshlrev_b32 v20, 5, v20
    v_lshl_add_u32 v18, v21, 4, v20
    v_and_b32 v20, 7, v0
    v_lshlrev_b32 v20, 5, v20
    v_lshl_add_u32 v20, v49, 2, v20
    v_bfe_u32 v22, v0, 3, 1
    v_lshl_add_u32 v11, v22, 4, v20
    s_and_b32 s72, s3, 1
    s_lshl_b32 s72, s72, 5
    s_add_u32 s72, s72, 131072
    v_lshlrev_b32 v20, 9, v49
    v_lshl_add_u32 v20, v50, 6, v20
    v_lshl_add_u32 v20, v51, 3, v20
    v_add_u32 v15, s72, v20
    s_mul_i32 s13, s4, 53376
    s_add_u32 s13, s13, 1048576
    s_sub_u32 s84, s13, s63
    s_lshl_b32 s72, s6, 10
    s_add_u32 s76, s84, s72
    s_lshl_b32 s72, s18, 8
    s_add_u32 s85, s13, s72
    s_lshl_b32 s72, s5, 5
    s_lshl_b32 s73, s3, 2
    s_add_u32 s72, s72, s73
    s_add_u32 s80, s13, 41088
    s_add_u32 s77, s80, s72
    s_and_b32 s73, s5, 1
    s_lshl_b32 s72, s73, 10
    s_add_u32 s80, s80, s72
    s_lshl_b32 s72, s3, 12
    s_add_u32 s72, s72, 8320
    s_add_u32 s78, s13, s72
    s_add_u32 s79, s84, s72
    s_lshl_b32 s72, s73, 14
    s_add_u32 s79, s79, s72
    s_lshr_b32 s72, s5, 4
    s_lshl_b32 s72, s72, 11
    s_add_u32 s78, s78, s72
    s_and_b32 s72, s5, 15
    s_lshl_b32 s72, s72, 4
    s_add_u32 s78, s78, s72
    s_and_b32 s81, s5, 30
    s_lshl_b32 s81, s81, 13
    s_lshl_b32 s72, s3, 12
    s_add_u32 s81, s81, s72
    s_lshl_b32 s72, s4, 8
    s_add_u32 s81, s81, s72
    s_lshl_b32 s72, s73, 7
    s_add_u32 s81, s81, s72
    s_add_u32 s81, s81, 1475584
    s_lshl_b32 s82, s5, 13
    s_lshl_b32 s72, s3, 11
    s_add_u32 s82, s82, s72
    s_add_u32 s82, s82, 1475584
    s_sub_u32 s82, s82, s63
    s_lshr_b32 s97, s5, 1
    s_lshl_b32 s83, s97, 10
    s_cmp_ge_u32 s97, 7
    s_cselect_b32 s72, 4294960256, 0
    s_add_u32 s83, s83, s72
    s_lshl_b32 s97, s97, 6
    s_lshl_b32 s73, s73, 1
    s_and_b32 s72, s3, 1
    s_add_u32 s73, s73, s72
    s_lshl_b32 s72, s73, 5
    s_add_u32 s83, s83, s72
    s_mul_i32 s72, s73, 1792
    s_add_u32 s97, s97, s72
    s_lshr_b32 s73, s3, 1
    s_lshl_b32 s72, s73, 9
    s_add_u32 s83, s83, s72
    s_lshl_b32 s72, s73, 5
    s_add_u32 s97, s97, s72
    s_add_u32 s83, s83, s13
    s_add_u32 s83, s83, 43136
    s_add_u32 s84, s84, 4294354048
    s_add_u32 s91, s13, 4294361216
    s_and_b32 s72, s5, 30
    s_add_u32 s72, s72, s73
    s_lshl_b32 s90, s72, 6
    s_and_b32 s72, s5, 1
    s_lshl_b32 s72, s72, 5
    s_add_u32 s90, s90, s72
    s_and_b32 s72, s3, 1
    s_lshl_b32 s72, s72, 4
    s_add_u32 s90, s90, s72
    s_add_u32 s90, s90, s13
    s_add_u32 s90, s90, 50304
    s_mov_b32 s54, 3706880
    v_mov_b32 v44, -1
    v_mov_b32 v45, -1
    v_mov_b32 v46, -1
    v_mov_b32 v47, -1
    s_cmp_lg_u32 s6, 4
    s_cbranch_scc1 Ldn_1
    s_cmp_lg_u32 s3, 2
    s_cbranch_scc1 Ldn_1
    s_mul_i32 s13, s4, 53376
    s_add_u32 s13, s13, 1048576
    s_sub_u32 s13, s13, s63
    s_lshl_b32 s73, s7, 11
    s_add_u32 s72, s13, s73
    buffer_store_dwordx4 v[44:47], v6, s[52:55], s72 offen sc1
    buffer_store_dwordx4 v[44:47], v6, s[52:55], s72 offen offset:1024 sc1
    s_lshl_b32 s72, s4, 2
    s_add_u32 s72, s72, s7
    s_lshl_b32 s72, s72, 10
    s_add_u32 s72, s72, 3674112
    s_sub_u32 s72, s72, s63
    buffer_store_dwordx4 v[44:47], v6, s[52:55], s72 offen sc1
Ldn_1:
    s_mov_b32 s11, -1
    s_mov_b32 s94, 3706880
    s_mov_b32 s56, s8
    s_mov_b32 s57, s9
    s_mov_b32 s58, 7168
    s_mov_b32 s59, 0x20000
    buffer_load_dword v16, v14, s[56:59], s97 offen
    s_add_u32 m0, s62, 8192
    s_nop 0
    s_waitcnt vmcnt(8)
    buffer_load_dwordx4 v1, s[36:39], s66 offen offset:0 nt lds
    v_xor_b32 v63, 32, v1
    s_waitcnt vmcnt(8)
    buffer_load_dwordx4 v63, s[36:39], s66 offen offset:1024 nt lds
    s_cmp_lg_u32 s6, 4
    s_cbranch_scc1 Lnl_2
    s_cmp_lg_u32 s3, 2
    s_cbranch_scc1 Lnl_2
    s_waitcnt vmcnt(3)
    s_lshl_b32 s72, s4, 2
    s_add_u32 s72, s72, s7
    s_lshl_b32 s72, s72, 2
    v_mov_b32 v24, s72
    v_mov_b32 v25, 1
    s_mov_b64 exec, 1
    global_store_dword v24, v25, s[30:31] sc1
    s_mov_b64 exec, -1
Lnl_2:
    s_cmp_lg_u32 s3, 2
    s_cbranch_scc1 Lnw_3
    s_mul_i32 s72, s4, 53376
    s_add_u32 s72, s72, 1048576
    s_sub_u32 s72, s72, s63
    s_mul_i32 s73, s5, 1408
    s_add_u32 s72, s72, s73
    s_add_u32 s72, s72, 8320
    buffer_store_dwordx4 v[44:47], v6, s[52:55], s72 offen sc1 nt
    s_mov_b64 exec, 0xffffff
    buffer_store_dwordx4 v[44:47], v6, s[52:55], s72 offen offset:1024 sc1 nt
    s_mov_b64 exec, -1
Lnw_3:
    s_cmp_lg_u32 s3, 3
    s_cbranch_scc1 Lnw_4
    s_mul_i32 s72, s2, 896
    s_add_u32 s72, s72, 2131968
    s_sub_u32 s72, s72, s63
    s_mov_b32 exec_hi, 0xffffff
    buffer_store_dwordx4 v[44:47], v6, s[52:55], s72 offen sc1 nt
    s_mov_b32 exec_hi, -1
Lnw_4:
    s_cmp_lg_u32 s3, 1
    s_cbranch_scc1 Lnw_5
    v_lshrrev_b32 v62, 4, v0
    s_mov_b32 s72, 656384
    v_mul_lo_u32 v62, v62, s72
    v_and_b32 v63, 15, v0
    v_lshl_add_u32 v62, v63, 4, v62
    s_mul_i32 s72, s4, 53376
    s_lshl_b32 s73, s5, 8
    s_add_u32 s72, s72, s73
    s_add_u32 s72, s72, 1704960
    s_mov_b32 exec_hi, 0xffff
    buffer_store_dwordx4 v[44:47], v62, s[52:55], s72 offen sc1 nt
    s_mov_b32 exec_hi, -1
Lnw_5:
    s_cmp_ge_u32 s5, 28
    s_cbranch_scc1 Lj28_6
    buffer_store_dword v44, v12, s[52:55], s81 offen sc1 nt
Lj28_6:
    v_xor_b32 v63, 64, v1
    s_waitcnt vmcnt(8)
    buffer_load_dwordx4 v63, s[36:39], s66 offen offset:2048 nt lds
    v_xor_b32 v63, 96, v1
    s_waitcnt vmcnt(8)
    buffer_load_dwordx4 v63, s[36:39], s66 offen offset:3072 nt lds
    s_cmp_ge_u32 s12, 16
    s_cselect_b32 s56, s24, s14
    s_cselect_b32 s57, s25, s15
    s_mov_b32 s58, 3670016
    s_mov_b32 s59, 0x20000
    s_mul_i32 s73, s3, 7
    s_add_u32 s73, s73, 0
    s_lshl_b32 s72, s73, 17
    s_lshl_b32 s73, s73, 10
    s_add_u32 s13, s73, 131072
    s_lshl_b32 s73, s4, 10
    s_add_u32 s72, s72, s73
    s_and_b32 s73, s12, 15
    s_lshl_b32 s73, s73, 6
    s_add_u32 s72, s72, s73
    v_lshrrev_b32 v63, 2, v0
    v_lshlrev_b32 v63, 13, v63
    v_and_b32 v62, 3, v0
    v_lshl_add_u32 v63, v62, 4, v63
    s_add_u32 m0, s13, 0
    s_nop 0
    s_waitcnt vmcnt(8)
    buffer_load_dwordx4 v63, s[56:59], s72 offen nt lds
    s_add_u32 m0, s13, 1024
    s_add_u32 s72, s72, 131072
    s_waitcnt vmcnt(8)
    buffer_load_dwordx4 v63, s[56:59], s72 offen nt lds
    s_add_u32 m0, s13, 2048
    s_add_u32 s72, s72, 131072
    s_waitcnt vmcnt(8)
    buffer_load_dwordx4 v63, s[56:59], s72 offen nt lds
    s_add_u32 m0, s13, 3072
    s_add_u32 s72, s72, 131072
    s_waitcnt vmcnt(8)
    buffer_load_dwordx4 v63, s[56:59], s72 offen nt lds
    v_xor_b32 v60, 64, v4
    v_xor_b32 v61, 128, v4
    v_xor_b32 v62, 192, v4
    ds_read_b128 a[0:3], v4 offset:0
    ds_read_b128 a[4:7], v60 offset:0
    ds_read_b128 a[8:11], v61 offset:0
    ds_read_b128 a[12:15], v62 offset:0
    ds_read_b128 a[16:19], v4 offset:256
    ds_read_b128 a[20:23], v60 offset:256
    ds_read_b128 a[24:27], v61 offset:256
    ds_read_b128 a[28:31], v62 offset:256
    s_add_u32 m0, s62, 12288
    v_xor_b32 v63, 128, v1
    s_waitcnt vmcnt(7)
    buffer_load_dwordx4 v63, s[36:39], s67 offen offset:0 nt lds
    v_xor_b32 v63, 160, v1
    s_waitcnt vmcnt(7)
    buffer_load_dwordx4 v63, s[36:39], s67 offen offset:1024 nt lds
    v_xor_b32 v63, 192, v1
    s_waitcnt vmcnt(7)
    buffer_load_dwordx4 v63, s[36:39], s67 offen offset:2048 nt lds
    v_xor_b32 v63, 224, v1
    s_waitcnt vmcnt(7)
    buffer_load_dwordx4 v63, s[36:39], s67 offen offset:3072 nt lds
    s_add_u32 m0, s62, 16384
    s_nop 0
    s_waitcnt vmcnt(7)
    buffer_load_dwordx4 v1, s[36:39], s68 offen offset:0 nt lds
    v_xor_b32 v63, 32, v1
    s_waitcnt vmcnt(7)
    buffer_load_dwordx4 v63, s[36:39], s68 offen offset:1024 nt lds
    v_xor_b32 v63, 64, v1
    s_waitcnt vmcnt(7)
    buffer_load_dwordx4 v63, s[36:39], s68 offen offset:2048 nt lds
    v_xor_b32 v63, 96, v1
    s_waitcnt vmcnt(7)
    buffer_load_dwordx4 v63, s[36:39], s68 offen offset:3072 nt lds
    s_cmp_ge_u32 s12, 16
    s_cselect_b32 s56, s24, s14
    s_cselect_b32 s57, s25, s15
    s_mov_b32 s58, 3670016
    s_mov_b32 s59, 0x20000
    s_mul_i32 s73, s3, 7
    s_add_u32 s73, s73, 4
    s_lshl_b32 s72, s73, 17
    s_lshl_b32 s73, s73, 10
    s_add_u32 s13, s73, 131072
    s_lshl_b32 s73, s4, 10
    s_add_u32 s72, s72, s73
    s_and_b32 s73, s12, 15
    s_lshl_b32 s73, s73, 6
    s_add_u32 s72, s72, s73
    v_lshrrev_b32 v63, 2, v0
    v_lshlrev_b32 v63, 13, v63
    v_and_b32 v62, 3, v0
    v_lshl_add_u32 v63, v62, 4, v63
    s_add_u32 m0, s13, 0
    s_nop 0
    s_waitcnt vmcnt(7)
    buffer_load_dwordx4 v63, s[56:59], s72 offen nt lds
    s_add_u32 m0, s13, 1024
    s_add_u32 s72, s72, 131072
    s_waitcnt vmcnt(7)
    buffer_load_dwordx4 v63, s[56:59], s72 offen nt lds
    s_add_u32 m0, s13, 2048
    s_add_u32 s72, s72, 131072
    s_waitcnt vmcnt(7)
    buffer_load_dwordx4 v63, s[56:59], s72 offen nt lds
    s_cmp_lg_u32 s19, 0
    s_cbranch_scc1 Lnq_7
    v_and_b32 v62, 7, v0
    v_mul_u32_u24 v62, 896, v62
    v_bfe_u32 v63, v0, 3, 1
    v_mul_u32_u24 v63, 448, v63
    v_add_u32 v62, v62, v63
    v_and_b32 v63, 48, v0
    v_add_u32 v62, v62, v63
    s_mov_b32 s56, s8
    s_mov_b32 s57, s9
    s_mov_b32 s58, 7168
    s_mov_b32 s59, 0x20000
    buffer_load_dwordx4 v[64:67], v62, s[56:59], 0 offen offset:0
    buffer_load_dwordx4 v[68:71], v62, s[56:59], 0 offen offset:64
    buffer_load_dwordx4 v[72:75], v62, s[56:59], 0 offen offset:128
    buffer_load_dwordx4 v[76:79], v62, s[56:59], 0 offen offset:192
    buffer_load_dwordx4 v[80:83], v62, s[56:59], 0 offen offset:256
    buffer_load_dwordx4 v[84:87], v62, s[56:59], 0 offen offset:320
    buffer_load_dwordx4 v[88:91], v62, s[56:59], 0 offen offset:384
Lnq_7:
    s_add_u32 m0, s62, 20480
    v_xor_b32 v63, 128, v1
    buffer_load_dwordx4 v63, s[36:39], s69 offen offset:0 nt lds
    v_xor_b32 v63, 160, v1
    buffer_load_dwordx4 v63, s[36:39], s69 offen offset:1024 nt lds
    v_and_b32 v26, 3, v0
    s_lshl_b32 s72, s4, 2
    v_add_lshl_u32 v26, v26, s72, 2
    global_load_dword v27, v26, s[30:31] sc1
    v_xor_b32 v63, 192, v1
    buffer_load_dwordx4 v63, s[36:39], s69 offen offset:2048 nt lds
    v_xor_b32 v63, 224, v1
    buffer_load_dwordx4 v63, s[36:39], s69 offen offset:3072 nt lds
    s_add_u32 m0, s62, 24576
    s_nop 0
    s_waitcnt vmcnt(12)
    buffer_load_dwordx4 v1, s[36:39], s70 offen offset:0 nt lds
    v_xor_b32 v60, 64, v4
    v_xor_b32 v61, 128, v4
    v_xor_b32 v62, 192, v4
    ds_read_b128 a[32:35], v4 offset:8192
    ds_read_b128 a[36:39], v60 offset:8192
    ds_read_b128 a[40:43], v61 offset:8192
    ds_read_b128 a[44:47], v62 offset:8192
    ds_read_b128 a[48:51], v4 offset:8448
    ds_read_b128 a[52:55], v60 offset:8448
    ds_read_b128 a[56:59], v61 offset:8448
    ds_read_b128 a[60:63], v62 offset:8448
    v_xor_b32 v63, 32, v1
    s_waitcnt vmcnt(12)
    buffer_load_dwordx4 v63, s[36:39], s70 offen offset:1024 nt lds
    v_xor_b32 v63, 64, v1
    s_waitcnt vmcnt(12)
    buffer_load_dwordx4 v63, s[36:39], s70 offen offset:2048 nt lds
    v_xor_b32 v63, 96, v1
    s_waitcnt vmcnt(12)
    buffer_load_dwordx4 v63, s[36:39], s70 offen offset:3072 nt lds
    s_waitcnt vmcnt(9)
    s_waitcnt vmcnt(6)
GATE_chk:
    v_cmp_eq_u32 vcc, 0, v27
    s_cbranch_vccz GATE_ok
    s_cmp_eq_u32 s74, 0
    s_cbranch_scc1 GATE_ok
    s_sub_u32 s74, s74, 1
    s_sleep 4
    global_load_dword v27, v26, s[30:31] sc1
    s_waitcnt vmcnt(0)
    s_branch GATE_chk
GATE_ok:
    s_barrier
    s_cmp_lg_u32 s3, 3
    s_cbranch_scc1 Lnw_8
    s_getreg_b32 s72, hwreg(HW_REG_XCC_ID, 0, 4)
    v_mov_b32 v24, s72
    v_lshlrev_b32 v25, 2, v0
    s_lshl_b32 s72, s4, 5
    s_add_u32 s72, s72, s5
    s_lshl_b32 s72, s72, 7
    s_add_u32 s72, s72, 3674112
    s_mov_b32 exec_hi, 0
    buffer_store_dword v24, v25, s[52:55], s72 offen sc1
    s_mov_b32 exec_hi, -1
Lnw_8:
    s_cmp_eq_u32 s19, 2
    s_cbranch_scc1 Lnq_9
    s_call_b64 s[60:61], CSUM
    s_cmp_lg_u32 s19, 0
    s_cbranch_scc1 Lnq_11
    ds_read_b64_tr_b16 v[32:33], v15 offset:0
    ds_read_b64_tr_b16 v[34:35], v15 offset:256
    ds_read_b64_tr_b16 v[36:37], v15 offset:14336
    ds_read_b64_tr_b16 v[38:39], v15 offset:14592
    ds_read_b64_tr_b16 v[40:41], v15 offset:2048
    ds_read_b64_tr_b16 v[42:43], v15 offset:2304
    ds_read_b64_tr_b16 v[44:45], v15 offset:16384
    ds_read_b64_tr_b16 v[46:47], v15 offset:16640
    ds_read_b64_tr_b16 v[56:57], v15 offset:4096
    ds_read_b64_tr_b16 v[58:59], v15 offset:4352
    ds_read_b64_tr_b16 v[60:61], v15 offset:18432
    ds_read_b64_tr_b16 v[62:63], v15 offset:18688
    ds_read_b64_tr_b16 v[92:93], v15 offset:6144
    ds_read_b64_tr_b16 v[94:95], v15 offset:6400
    v_mov_b64 v[20:21], 0
    v_mov_b64 v[22:23], 0
    v_mov_b64 v[24:25], 0
    v_mov_b64 v[26:27], 0
    s_mov_b32 s72, 1065369472
    v_dot2c_f32_bf16 v20, s72, v64
    v_dot2c_f32_bf16 v21, v64, v64
    v_dot2c_f32_bf16 v22, s72, v65
    v_dot2c_f32_bf16 v23, v65, v65
    v_dot2c_f32_bf16 v20, s72, v66
    v_dot2c_f32_bf16 v21, v66, v66
    v_dot2c_f32_bf16 v22, s72, v67
    v_dot2c_f32_bf16 v23, v67, v67
    v_dot2c_f32_bf16 v20, s72, v68
    v_dot2c_f32_bf16 v21, v68, v68
    v_dot2c_f32_bf16 v22, s72, v69
    v_dot2c_f32_bf16 v23, v69, v69
    v_dot2c_f32_bf16 v20, s72, v70
    v_dot2c_f32_bf16 v21, v70, v70
    v_dot2c_f32_bf16 v22, s72, v71
    v_dot2c_f32_bf16 v23, v71, v71
    v_dot2c_f32_bf16 v20, s72, v72
    v_dot2c_f32_bf16 v21, v72, v72
    v_dot2c_f32_bf16 v22, s72, v73
    v_dot2c_f32_bf16 v23, v73, v73
    v_dot2c_f32_bf16 v20, s72, v74
    v_dot2c_f32_bf16 v21, v74, v74
    v_dot2c_f32_bf16 v22, s72, v75
    v_dot2c_f32_bf16 v23, v75, v75
    v_dot2c_f32_bf16 v20, s72, v76
    v_dot2c_f32_bf16 v21, v76, v76
    v_dot2c_f32_bf16 v22, s72, v77
    v_dot2c_f32_bf16 v23, v77, v77
    v_dot2c_f32_bf16 v20, s72, v78
    v_dot2c_f32_bf16 v21, v78, v78
    v_dot2c_f32_bf16 v22, s72, v79
    v_dot2c_f32_bf16 v23, v79, v79
    v_dot2c_f32_bf16 v20, s72, v80
    v_dot2c_f32_bf16 v21, v80, v80
    v_dot2c_f32_bf16 v22, s72, v81
    v_dot2c_f32_bf16 v23, v81, v81
    v_dot2c_f32_bf16 v20, s72, v82
    v_dot2c_f32_bf16 v21, v82, v82
    v_dot2c_f32_bf16 v22, s72, v83
    v_dot2c_f32_bf16 v23, v83, v83
    v_dot2c_f32_bf16 v20, s72, v84
    v_dot2c_f32_bf16 v21, v84, v84
    v_dot2c_f32_bf16 v22, s72, v85
    v_dot2c_f32_bf16 v23, v85, v85
    v_dot2c_f32_bf16 v20, s72, v86
    v_dot2c_f32_bf16 v21, v86, v86
    v_dot2c_f32_bf16 v22, s72, v87
    v_dot2c_f32_bf16 v23, v87, v87
    v_dot2c_f32_bf16 v20, s72, v88
    v_dot2c_f32_bf16 v21, v88, v88
    v_dot2c_f32_bf16 v22, s72, v89
    v_dot2c_f32_bf16 v23, v89, v89
    v_dot2c_f32_bf16 v20, s72, v90
    v_dot2c_f32_bf16 v21, v90, v90
    v_dot2c_f32_bf16 v22, s72, v91
    v_dot2c_f32_bf16 v23, v91, v91
    s_nop 2
    s_call_b64 s[60:61], QP_go
Lnq_11:
    s_branch Ldn_10
Lnq_9:
Ldn_10:
    v_mov_b32 v44, -1
    v_mov_b32 v45, -1
    v_mov_b32 v46, -1
    v_mov_b32 v47, -1
    v_and_b32 v20, 7, v0
    v_mul_u32_u24 v20, 992, v20
    v_add_u32 v11, v11, v20
    s_mul_i32 s72, s18, 224
    s_sub_u32 s85, s85, s72
    s_add_u32 m0, s62, 28672
    v_xor_b32 v63, 128, v1
    buffer_load_dwordx4 v63, s[36:39], s71 offen offset:0 nt lds
    v_xor_b32 v63, 160, v1
    buffer_load_dwordx4 v63, s[36:39], s71 offen offset:1024 nt lds
    v_xor_b32 v63, 192, v1
    s_waitcnt vmcnt(7)
    buffer_load_dwordx4 v63, s[36:39], s71 offen offset:2048 nt lds
    v_xor_b32 v63, 224, v1
    s_waitcnt vmcnt(7)
    buffer_load_dwordx4 v63, s[36:39], s71 offen offset:3072 nt lds
    v_xor_b32 v60, 64, v4
    v_xor_b32 v61, 128, v4
    v_xor_b32 v62, 192, v4
    ds_read_b128 a[64:67], v4 offset:16384
    ds_read_b128 a[68:71], v60 offset:16384
    ds_read_b128 a[72:75], v61 offset:16384
    ds_read_b128 a[76:79], v62 offset:16384
    ds_read_b128 a[80:83], v4 offset:16640
    ds_read_b128 a[84:87], v60 offset:16640
    ds_read_b128 a[88:91], v61 offset:16640
    ds_read_b128 a[92:95], v62 offset:16640
    s_waitcnt lgkmcnt(0)
    s_add_u32 m0, s62, 0
    s_nop 0
    s_waitcnt vmcnt(7)
    buffer_load_dwordx4 v2, s[40:43], s64 offen offset:0 nt lds
    s_add_u32 s72, s64, 3072
    s_waitcnt vmcnt(7)
    buffer_load_dwordx4 v2, s[40:43], s72 offen offset:1024 nt lds
    s_add_u32 s72, s64, 6144
    s_waitcnt vmcnt(7)
    buffer_load_dwordx4 v2, s[40:43], s72 offen offset:2048 nt lds
    s_add_u32 s72, s64, 9216
    s_waitcnt vmcnt(7)
    buffer_load_dwordx4 v2, s[40:43], s72 offen offset:3072 nt lds
    s_cmp_ge_u32 s5, 28
    s_cbranch_scc1 Lj28_12
    s_mov_b32 s56, s16
    s_mov_b32 s57, s17
    s_mov_b32 s58, 3670016
    s_mov_b32 s59, 0x20000
    s_lshl_b32 s72, s4, 1
    s_and_b32 s73, s5, 1
    s_add_u32 s72, s72, s73
    s_lshl_b32 s72, s72, 2
    s_add_u32 s72, s72, s3
    s_mul_i32 s72, s72, 57344
    s_lshr_b32 s73, s5, 1
    s_lshl_b32 s73, s73, 6
    s_add_u32 s72, s72, s73
    v_and_b32 v63, 15, v0
    v_mul_u32_u24 v63, 896, v63
    v_and_b32 v62, 48, v0
    v_add_u32 v63, v62, v63
    buffer_load_dwordx4 v[112:115], v63, s[56:59], s72 offen nt
    s_add_u32 s72, s72, 14336
    buffer_load_dwordx4 v[116:119], v63, s[56:59], s72 offen nt
    s_add_u32 s72, s72, 14336
    buffer_load_dwordx4 v[120:123], v63, s[56:59], s72 offen nt
    s_add_u32 s72, s72, 14336
    buffer_load_dwordx4 v[124:127], v63, s[56:59], s72 offen nt
Lj28_12:
    s_add_u32 m0, s62, 4096
    s_nop 0
    s_waitcnt vmcnt(7)
    buffer_load_dwordx4 v3, s[40:43], s65 offen offset:0 nt lds
    s_add_u32 s72, s65, 3072
    s_waitcnt vmcnt(7)
    buffer_load_dwordx4 v3, s[40:43], s72 offen offset:1024 nt lds
    s_add_u32 s72, s65, 6144
    s_waitcnt vmcnt(7)
    buffer_load_dwordx4 v3, s[40:43], s72 offen offset:2048 nt lds
    s_add_u32 s72, s65, 9216
    s_waitcnt vmcnt(7)
    buffer_load_dwordx4 v3, s[40:43], s72 offen offset:3072 nt lds
    v_xor_b32 v60, 64, v4
    v_xor_b32 v61, 128, v4
    v_xor_b32 v62, 192, v4
    ds_read_b128 a[96:99], v4 offset:24576
    ds_read_b128 a[100:103], v60 offset:24576
    ds_read_b128 a[104:107], v61 offset:24576
    ds_read_b128 a[108:111], v62 offset:24576
    ds_read_b128 a[112:115], v4 offset:24832
    ds_read_b128 a[116:119], v60 offset:24832
    ds_read_b128 a[120:123], v61 offset:24832
    ds_read_b128 a[124:127], v62 offset:24832
    s_add_u32 m0, s62, 8192
    s_nop 0
    s_waitcnt vmcnt(7)
    buffer_load_dwordx4 v2, s[40:43], s66 offen offset:0 nt lds
    s_add_u32 s72, s66, 3072
    s_waitcnt vmcnt(7)
    buffer_load_dwordx4 v2, s[40:43], s72 offen offset:1024 nt lds
    s_add_u32 s72, s66, 6144
    s_waitcnt vmcnt(7)
    buffer_load_dwordx4 v2, s[40:43], s72 offen offset:2048 nt lds
    s_add_u32 s72, s66, 9216
    s_waitcnt vmcnt(7)
    buffer_load_dwordx4 v2, s[40:43], s72 offen offset:3072 nt lds
    s_add_u32 m0, s62, 12288
    s_nop 0
    s_waitcnt vmcnt(7)
    buffer_load_dwordx4 v3, s[40:43], s67 offen offset:0 nt lds
    s_add_u32 s72, s67, 3072
    s_waitcnt vmcnt(7)
    buffer_load_dwordx4 v3, s[40:43], s72 offen offset:1024 nt lds
    s_add_u32 s72, s67, 6144
    s_waitcnt vmcnt(7)
    buffer_load_dwordx4 v3, s[40:43], s72 offen offset:2048 nt lds
    s_add_u32 s72, s67, 9216
    s_waitcnt vmcnt(7)
    buffer_load_dwordx4 v3, s[40:43], s72 offen offset:3072 nt lds
    s_call_b64 s[60:61], VC_0
    s_add_u32 m0, s62, 16384
    s_nop 0
    s_waitcnt vmcnt(7)
    buffer_load_dwordx4 v2, s[40:43], s68 offen offset:0 nt lds
    s_mov_b32 s36, 10
    s_mov_b32 s37, 0
    s_mov_b32 s7, 0
    s_add_u32 s72, s68, 3072
    s_waitcnt vmcnt(7)
    buffer_load_dwordx4 v2, s[40:43], s72 offen offset:1024 nt lds
    s_call_b64 s[0:1], HND
    s_add_u32 s72, s68, 6144
    s_waitcnt vmcnt(7)
    buffer_load_dwordx4 v2, s[40:43], s72 offen offset:2048 nt lds
    s_add_u32 s72, s68, 9216
    s_waitcnt vmcnt(7)
    buffer_load_dwordx4 v2, s[40:43], s72 offen offset:3072 nt lds
    s_call_b64 s[0:1], HND
    s_add_u32 m0, s62, 20480
    s_nop 0
    s_waitcnt vmcnt(7)
    buffer_load_dwordx4 v3, s[40:43], s69 offen offset:0 nt lds
    s_add_u32 s72, s69, 3072
    s_waitcnt vmcnt(7)
    buffer_load_dwordx4 v3, s[40:43], s72 offen offset:1024 nt lds
    s_call_b64 s[0:1], HND
    s_add_u32 s72, s69, 6144
    s_waitcnt vmcnt(7)
    buffer_load_dwordx4 v3, s[40:43], s72 offen offset:2048 nt lds
    s_add_u32 s72, s69, 9216
    s_waitcnt vmcnt(7)
    buffer_load_dwordx4 v3, s[40:43], s72 offen offset:3072 nt lds
    s_call_b64 s[60:61], VC_1
    s_call_b64 s[0:1], HND
    s_waitcnt lgkmcnt(0)
    s_add_u32 m0, s62, 24576
    s_nop 0
    s_waitcnt vmcnt(7)
    buffer_load_dwordx4 v2, s[40:43], s70 offen offset:0 nt lds
    s_add_u32 s72, s70, 3072
    s_waitcnt vmcnt(7)
    buffer_load_dwordx4 v2, s[40:43], s72 offen offset:1024 nt lds
    s_call_b64 s[0:1], HND
    s_add_u32 s72, s70, 6144
    s_waitcnt vmcnt(7)
    buffer_load_dwordx4 v2, s[40:43], s72 offen offset:2048 nt lds
    s_add_u32 s72, s70, 9216
    s_waitcnt vmcnt(7)
    buffer_load_dwordx4 v2, s[40:43], s72 offen offset:3072 nt lds
    s_call_b64 s[0:1], HND
    s_add_u32 m0, s62, 28672
    s_nop 0
    s_waitcnt vmcnt(7)
    buffer_load_dwordx4 v3, s[40:43], s71 offen offset:0 nt lds
    s_add_u32 s72, s71, 3072
    s_waitcnt vmcnt(7)
    buffer_load_dwordx4 v3, s[40:43], s72 offen offset:1024 nt lds
    s_call_b64 s[0:1], HND
    s_add_u32 s72, s71, 6144
    s_waitcnt vmcnt(7)
    buffer_load_dwordx4 v3, s[40:43], s72 offen offset:2048 nt lds
    s_add_u32 s72, s71, 9216
    s_waitcnt vmcnt(7)
    buffer_load_dwordx4 v3, s[40:43], s72 offen offset:3072 nt lds
    s_call_b64 s[60:61], VC_2
    s_call_b64 s[0:1], HND
    s_add_u32 m0, s62, 0
    s_nop 0
    s_waitcnt vmcnt(7)
    buffer_load_dwordx4 v1, s[44:47], s64 offen offset:0 nt lds
    v_xor_b32 v63, 32, v1
    s_waitcnt vmcnt(7)
    buffer_load_dwordx4 v63, s[44:47], s64 offen offset:1024 nt lds
    s_call_b64 s[0:1], HND
    v_xor_b32 v63, 64, v1
    s_waitcnt vmcnt(7)
    buffer_load_dwordx4 v63, s[44:47], s64 offen offset:2048 nt lds
    v_xor_b32 v63, 96, v1
    s_waitcnt vmcnt(7)
    buffer_load_dwordx4 v63, s[44:47], s64 offen offset:3072 nt lds
    s_call_b64 s[0:1], HND
    s_add_u32 m0, s62, 4096
    v_xor_b32 v63, 128, v1
    s_waitcnt vmcnt(7)
    buffer_load_dwordx4 v63, s[44:47], s65 offen offset:0 nt lds
    v_xor_b32 v63, 160, v1
    s_waitcnt vmcnt(7)
    buffer_load_dwordx4 v63, s[44:47], s65 offen offset:1024 nt lds
    s_call_b64 s[0:1], HND
    v_xor_b32 v63, 192, v1
    s_waitcnt vmcnt(7)
    buffer_load_dwordx4 v63, s[44:47], s65 offen offset:2048 nt lds
    v_xor_b32 v63, 224, v1
    s_waitcnt vmcnt(7)
    buffer_load_dwordx4 v63, s[44:47], s65 offen offset:3072 nt lds
    s_call_b64 s[60:61], VC_3
    s_cmp_eq_u32 s36, 8
    s_cbranch_scc1 Lq1_13
    s_call_b64 s[0:1], Q1_poll
Lq1_13:
    s_waitcnt lgkmcnt(0)
    v_and_b32 v25, 0xffffff6f, v9
    v_and_b32 v23, 0xfffff000, v9
    s_call_b64 s[60:61], PV
    s_call_b64 s[60:61], WOT
    v_and_b32 v26, 7, v0
    v_lshlrev_b32 v26, 2, v26
    global_load_dword v27, v26, s[30:31] offset:128 sc1
    s_mov_b32 s36, 0
    s_mov_b32 s37, 0
    s_mov_b32 s38, 0
    s_mov_b32 s39, 0
    s_cmp_lt_u32 s5, 28
    s_cbranch_scc1 Llt28_14
    s_call_b64 s[60:61], ADV
    s_cmp_eq_u32 s19, 1
    s_cselect_b32 s36, 4, 6
    s_cselect_b32 s37, 99, 20
Llt28_14:
    s_cmp_ge_u32 s12, 16
    s_cselect_b32 s40, 6, 4
    s_cselect_b32 s41, 1, 0
    s_mov_b32 s39, 1
    s_call_b64 s[0:1], HND
    s_add_u32 m0, s62, 8192
    s_nop 0
    s_waitcnt vmcnt(8)
    buffer_load_dwordx4 v1, s[44:47], s66 offen offset:0 nt lds
    v_xor_b32 v63, 32, v1
    s_waitcnt vmcnt(8)
    buffer_load_dwordx4 v63, s[44:47], s66 offen offset:1024 nt lds
    s_call_b64 s[0:1], HND
    v_xor_b32 v63, 64, v1
    s_waitcnt vmcnt(8)
    buffer_load_dwordx4 v63, s[44:47], s66 offen offset:2048 nt lds
    v_xor_b32 v63, 96, v1
    s_waitcnt vmcnt(8)
    buffer_load_dwordx4 v63, s[44:47], s66 offen offset:3072 nt lds
    s_call_b64 s[0:1], HND
    s_add_u32 m0, s62, 12288
    v_xor_b32 v63, 128, v1
    s_waitcnt vmcnt(8)
    buffer_load_dwordx4 v63, s[44:47], s67 offen offset:0 nt lds
    v_xor_b32 v63, 160, v1
    s_waitcnt vmcnt(8)
    buffer_load_dwordx4 v63, s[44:47], s67 offen offset:1024 nt lds
    s_call_b64 s[0:1], HND
    v_xor_b32 v63, 192, v1
    s_waitcnt vmcnt(8)
    buffer_load_dwordx4 v63, s[44:47], s67 offen offset:2048 nt lds
    v_xor_b32 v63, 224, v1
    s_waitcnt vmcnt(8)
    buffer_load_dwordx4 v63, s[44:47], s67 offen offset:3072 nt lds
    v_xor_b32 v60, 64, v4
    v_xor_b32 v61, 128, v4
    v_xor_b32 v62, 192, v4
    ds_read_b128 a[128:131], v4 offset:0
    ds_read_b128 a[132:135], v60 offset:0
    ds_read_b128 a[136:139], v61 offset:0
    ds_read_b128 a[140:143], v62 offset:0
    ds_read_b128 a[144:147], v4 offset:256
    ds_read_b128 a[148:151], v60 offset:256
    ds_read_b128 a[152:155], v61 offset:256
    ds_read_b128 a[156:159], v62 offset:256
    s_call_b64 s[0:1], HND
    s_add_u32 m0, s62, 16384
    s_nop 0
    s_waitcnt vmcnt(7)
    buffer_load_dwordx4 v1, s[44:47], s68 offen offset:0 nt lds
    v_xor_b32 v63, 32, v1
    s_waitcnt vmcnt(7)
    buffer_load_dwordx4 v63, s[44:47], s68 offen offset:1024 nt lds
    s_call_b64 s[0:1], HND
    v_xor_b32 v63, 64, v1
    s_waitcnt vmcnt(7)
    buffer_load_dwordx4 v63, s[44:47], s68 offen offset:2048 nt lds
    v_xor_b32 v63, 96, v1
    s_waitcnt vmcnt(7)
    buffer_load_dwordx4 v63, s[44:47], s68 offen offset:3072 nt lds
    s_call_b64 s[0:1], HND
    s_add_u32 m0, s62, 20480
    v_xor_b32 v63, 128, v1
    s_waitcnt vmcnt(7)
    buffer_load_dwordx4 v63, s[44:47], s69 offen offset:0 nt lds
    v_xor_b32 v63, 160, v1
    s_waitcnt vmcnt(7)
    buffer_load_dwordx4 v63, s[44:47], s69 offen offset:1024 nt lds
    s_call_b64 s[0:1], HND
    v_xor_b32 v63, 192, v1
    s_waitcnt vmcnt(7)
    buffer_load_dwordx4 v63, s[44:47], s69 offen offset:2048 nt lds
    v_xor_b32 v63, 224, v1
    s_waitcnt vmcnt(7)
    buffer_load_dwordx4 v63, s[44:47], s69 offen offset:3072 nt lds
    v_xor_b32 v60, 64, v4
    v_xor_b32 v61, 128, v4
    v_xor_b32 v62, 192, v4
    ds_read_b128 a[160:163], v4 offset:8192
    ds_read_b128 a[164:167], v60 offset:8192
    ds_read_b128 a[168:171], v61 offset:8192
    ds_read_b128 a[172:175], v62 offset:8192
    ds_read_b128 a[176:179], v4 offset:8448
    ds_read_b128 a[180:183], v60 offset:8448
    ds_read_b128 a[184:187], v61 offset:8448
    ds_read_b128 a[188:191], v62 offset:8448
    s_call_b64 s[0:1], HND
    s_add_u32 m0, s62, 24576
    s_nop 0
    s_waitcnt vmcnt(7)
    buffer_load_dwordx4 v1, s[44:47], s70 offen offset:0 nt lds
    v_xor_b32 v63, 32, v1
    buffer_load_dwordx4 v63, s[44:47], s70 offen offset:1024 nt lds
    s_call_b64 s[0:1], HND
    v_xor_b32 v63, 64, v1
    buffer_load_dwordx4 v63, s[44:47], s70 offen offset:2048 nt lds
    v_xor_b32 v63, 96, v1
    buffer_load_dwordx4 v63, s[44:47], s70 offen offset:3072 nt lds
    s_call_b64 s[0:1], HND
    s_add_u32 m0, s62, 28672
    v_xor_b32 v63, 128, v1
    buffer_load_dwordx4 v63, s[44:47], s71 offen offset:0 nt lds
    v_xor_b32 v63, 160, v1
    buffer_load_dwordx4 v63, s[44:47], s71 offen offset:1024 nt lds
    s_call_b64 s[0:1], HND
    v_xor_b32 v63, 192, v1
    buffer_load_dwordx4 v63, s[44:47], s71 offen offset:2048 nt lds
    v_xor_b32 v63, 224, v1
    s_waitcnt vmcnt(13)
    buffer_load_dwordx4 v63, s[44:47], s71 offen offset:3072 nt lds
    s_call_b64 s[0:1], HND
    s_waitcnt lgkmcnt(0)
    s_add_u32 m0, s62, 0
    s_nop 0
    s_waitcnt vmcnt(13)
    buffer_load_dwordx4 v2, s[48:51], s64 offen offset:0 nt lds
    s_add_u32 s72, s64, 3072
    s_waitcnt vmcnt(13)
    buffer_load_dwordx4 v2, s[48:51], s72 offen offset:1024 nt lds
    s_call_b64 s[0:1], HND
    s_add_u32 s72, s64, 6144
    s_waitcnt vmcnt(13)
    buffer_load_dwordx4 v2, s[48:51], s72 offen offset:2048 nt lds
    s_add_u32 s72, s64, 9216
    s_waitcnt vmcnt(13)
    buffer_load_dwordx4 v2, s[48:51], s72 offen offset:3072 nt lds
    s_call_b64 s[0:1], HND
    s_add_u32 m0, s62, 4096
    s_nop 0
    s_waitcnt vmcnt(13)
    buffer_load_dwordx4 v3, s[48:51], s65 offen offset:0 nt lds
    s_add_u32 s72, s65, 3072
    s_waitcnt vmcnt(13)
    buffer_load_dwordx4 v3, s[48:51], s72 offen offset:1024 nt lds
    v_xor_b32 v60, 64, v4
    v_xor_b32 v61, 128, v4
    v_xor_b32 v62, 192, v4
    ds_read_b128 a[192:195], v4 offset:16384
    ds_read_b128 a[196:199], v60 offset:16384
    ds_read_b128 a[200:203], v61 offset:16384
    ds_read_b128 a[204:207], v62 offset:16384
    ds_read_b128 a[208:211], v4 offset:16640
    ds_read_b128 a[212:215], v60 offset:16640
    ds_read_b128 a[216:219], v61 offset:16640
    ds_read_b128 a[220:223], v62 offset:16640
    s_mov_b32 s38, 1
    s_call_b64 s[0:1], HND
    s_add_u32 s72, s65, 6144
    s_waitcnt vmcnt(13)
    buffer_load_dwordx4 v3, s[48:51], s72 offen offset:2048 nt lds
    s_add_u32 s72, s65, 9216
    s_waitcnt vmcnt(13)
    buffer_load_dwordx4 v3, s[48:51], s72 offen offset:3072 nt lds
    s_call_b64 s[0:1], HND
    s_add_u32 m0, s62, 8192
    s_nop 0
    s_waitcnt vmcnt(13)
    buffer_load_dwordx4 v2, s[48:51], s66 offen offset:0 nt lds
    s_add_u32 s72, s66, 3072
    s_waitcnt vmcnt(13)
    buffer_load_dwordx4 v2, s[48:51], s72 offen offset:1024 nt lds
    s_call_b64 s[0:1], HND
    s_add_u32 s72, s66, 6144
    s_waitcnt vmcnt(13)
    buffer_load_dwordx4 v2, s[48:51], s72 offen offset:2048 nt lds
    s_add_u32 s72, s66, 9216
    s_waitcnt vmcnt(13)
    buffer_load_dwordx4 v2, s[48:51], s72 offen offset:3072 nt lds
    s_call_b64 s[0:1], HND
    s_add_u32 m0, s62, 12288
    s_nop 0
    s_waitcnt vmcnt(13)
    buffer_load_dwordx4 v3, s[48:51], s67 offen offset:0 nt lds
    s_add_u32 s72, s67, 3072
    s_waitcnt vmcnt(13)
    buffer_load_dwordx4 v3, s[48:51], s72 offen offset:1024 nt lds
    v_xor_b32 v60, 64, v4
    v_xor_b32 v61, 128, v4
    v_xor_b32 v62, 192, v4
    ds_read_b128 a[224:227], v4 offset:24576
    ds_read_b128 a[228:231], v60 offset:24576
    ds_read_b128 a[232:235], v61 offset:24576
    ds_read_b128 a[236:239], v62 offset:24576
    ds_read_b128 a[240:243], v4 offset:24832
    ds_read_b128 a[244:247], v60 offset:24832
    ds_read_b128 a[248:251], v61 offset:24832
    ds_read_b128 a[252:255], v62 offset:24832
    s_mov_b32 s38, 2
    s_call_b64 s[0:1], HND
    s_add_u32 s72, s67, 6144
    s_waitcnt vmcnt(13)
    buffer_load_dwordx4 v3, s[48:51], s72 offen offset:2048 nt lds
    s_add_u32 s72, s67, 9216
    s_waitcnt vmcnt(13)
    buffer_load_dwordx4 v3, s[48:51], s72 offen offset:3072 nt lds
    s_call_b64 s[0:1], HND
    s_waitcnt lgkmcnt(0)
    s_add_u32 m0, s62, 16384
    s_nop 0
    s_waitcnt vmcnt(13)
    buffer_load_dwordx4 v2, s[48:51], s68 offen offset:0 nt lds
    s_add_u32 s72, s68, 3072
    s_waitcnt vmcnt(13)
    buffer_load_dwordx4 v2, s[48:51], s72 offen offset:1024 nt lds
    s_call_b64 s[0:1], HND
    s_add_u32 s72, s68, 6144
    s_waitcnt vmcnt(13)
    buffer_load_dwordx4 v2, s[48:51], s72 offen offset:2048 nt lds
    s_add_u32 s72, s68, 9216
    s_waitcnt vmcnt(13)
    buffer_load_dwordx4 v2, s[48:51], s72 offen offset:3072 nt lds
    s_call_b64 s[0:1], HND
    s_cmp_ge_u32 s5, 28
    s_cbranch_scc1 Lj28_15
    v_mov_b64 v[48:49], -1
    v_mov_b64 v[50:51], -1
    s_cmp_lt_u32 s3, 2
    s_cbranch_scc1 Llr_16
    s_mul_i32 s72, s4, 53376
    s_add_u32 s72, s72, 1048576
    s_sub_u32 s72, s72, s63
    s_mul_i32 s73, s3, 656384
    s_add_u32 s72, s72, s73
    s_mul_i32 s73, s5, 1872
    s_add_u32 s72, s72, s73
    buffer_store_dwordx4 v[48:51], v6, s[20:23], s72 offen
    buffer_store_dwordx4 v[48:51], v6, s[92:95], s72 offen  sc1
    s_mov_b32 exec_hi, 0x1fffff
    buffer_store_dwordx4 v[48:51], v6, s[20:23], s72 offen offset:1024
    buffer_store_dwordx4 v[48:51], v6, s[92:95], s72 offen offset:1024 sc1
    s_mov_b32 exec_hi, -1
    s_branch Ldn_17
Llr_16:
    s_mul_i32 s72, s3, 656384
    s_lshl_b32 s73, s2, 10
    s_add_u32 s72, s72, s73
    s_add_u32 s72, s72, 2788352
    s_sub_u32 s72, s72, s63
    buffer_store_dwordx4 v[48:51], v6, s[52:55], s72 offen sc1
Ldn_17:
Lj28_15:
    s_add_u32 m0, s62, 20480
    s_nop 0
    s_waitcnt vmcnt(13)
    buffer_load_dwordx4 v3, s[48:51], s69 offen offset:0 nt lds
    s_add_u32 s72, s69, 3072
    s_waitcnt vmcnt(13)
    buffer_load_dwordx4 v3, s[48:51], s72 offen offset:1024 nt lds
    s_call_b64 s[0:1], HND
    s_add_u32 s72, s69, 6144
    s_waitcnt vmcnt(13)
    buffer_load_dwordx4 v3, s[48:51], s72 offen offset:2048 nt lds
    s_add_u32 s72, s69, 9216
    s_waitcnt vmcnt(13)
    buffer_load_dwordx4 v3, s[48:51], s72 offen offset:3072 nt lds
    s_call_b64 s[0:1], HND
    s_add_u32 m0, s62, 24576
    s_nop 0
    s_waitcnt vmcnt(13)
    buffer_load_dwordx4 v2, s[48:51], s70 offen offset:0 nt lds
    s_add_u32 s72, s70, 3072
    s_waitcnt vmcnt(13)
    buffer_load_dwordx4 v2, s[48:51], s72 offen offset:1024 nt lds
    s_call_b64 s[0:1], HND
    s_add_u32 s72, s70, 6144
    s_waitcnt vmcnt(13)
    buffer_load_dwordx4 v2, s[48:51], s72 offen offset:2048 nt lds
    s_add_u32 s72, s70, 9216
    s_waitcnt vmcnt(13)
    buffer_load_dwordx4 v2, s[48:51], s72 offen offset:3072 nt lds
    s_call_b64 s[0:1], HND
    s_add_u32 m0, s62, 28672
    s_nop 0
    s_waitcnt vmcnt(13)
    buffer_load_dwordx4 v3, s[48:51], s71 offen offset:0 nt lds
    s_add_u32 s72, s71, 3072
    s_waitcnt vmcnt(13)
    buffer_load_dwordx4 v3, s[48:51], s72 offen offset:1024 nt lds
    s_call_b64 s[0:1], HND
    s_add_u32 s72, s71, 6144
    s_waitcnt vmcnt(13)
    buffer_load_dwordx4 v3, s[48:51], s72 offen offset:2048 nt lds
    s_add_u32 s72, s71, 9216
    s_waitcnt vmcnt(13)
    buffer_load_dwordx4 v3, s[48:51], s72 offen offset:3072 nt lds
    s_call_b64 s[0:1], HND
    s_waitcnt lgkmcnt(0)
    s_cmp_lg_u32 s3, 3
    s_cbranch_scc1 Lnw_18
    v_mul_u32_u24 v63, 79, v0
    v_lshrrev_b32 v63, 10, v63
    v_mul_u32_u24 v62, 13, v63
    v_sub_u32 v62, v0, v62
    s_mov_b32 s72, 656384
    v_mul_lo_u32 v63, v63, s72
    v_lshl_add_u32 v63, v62, 7, v63
    s_mul_i32 s72, s4, 53376
    s_mul_i32 s73, s5, 1664
    s_add_u32 s72, s72, s73
    s_add_u32 s72, s72, 1048576
    buffer_load_dword v1, v63, s[52:55], s72 offen sc1
Lnw_18:
    s_cmp_gt_u32 s36, 1
    s_cbranch_scc1 Lfin_19
    s_waitcnt vmcnt(0)
F2_chk:
    v_cmp_eq_u32 vcc, 0, v27
    s_cbranch_vccz F2_ok
    s_cmp_eq_u32 s74, 0
    s_cbranch_scc1 F2_ok
    s_sub_u32 s74, s74, 1
    s_sleep 4
    global_load_dword v27, v26, s[30:31] offset:128 sc1
    s_waitcnt vmcnt(0)
    s_branch F2_chk
F2_ok:
    s_call_b64 s[60:61], WO_poll
Lfin_19:
    s_mov_b32 s56, s26
    s_mov_b32 s57, s27
    s_mov_b32 s58, 3670016
    s_mov_b32 s59, 0x20000
    s_cmp_ge_u32 s5, 28
    s_cselect_b32 s58, 0, s58
    s_lshl_b32 s72, s4, 1
    s_and_b32 s73, s5, 1
    s_add_u32 s72, s72, s73
    s_lshl_b32 s72, s72, 2
    s_add_u32 s72, s72, s3
    s_mul_i32 s72, s72, 57344
    s_lshr_b32 s73, s5, 1
    s_lshl_b32 s73, s73, 6
    s_add_u32 s72, s72, s73
    v_and_b32 v63, 15, v0
    v_mul_u32_u24 v63, 896, v63
    v_and_b32 v62, 48, v0
    v_add_u32 v63, v62, v63
    buffer_load_dwordx4 v[112:115], v63, s[56:59], s72 offen nt
    s_add_u32 s72, s72, 14336
    buffer_load_dwordx4 v[116:119], v63, s[56:59], s72 offen nt
    s_add_u32 s72, s72, 14336
    buffer_load_dwordx4 v[120:123], v63, s[56:59], s72 offen nt
    s_add_u32 s72, s72, 14336
    buffer_load_dwordx4 v[124:127], v63, s[56:59], s72 offen nt
    s_cmp_gt_u32 s36, 3
    s_cbranch_scc1 Lfin_20
    s_call_b64 s[60:61], H3_poll
    s_cmp_eq_u32 s19, 1
    s_cselect_b32 s36, 4, 6
    s_cselect_b32 s37, 0, 4
Lfin_20:
    s_cmp_gt_u32 s36, 5
    s_cbranch_scc1 Lfin_21
    s_call_b64 s[60:61], QP_first
Lfin_21:
    s_cmp_eq_u32 s36, 8
    s_cbranch_scc1 Lfin_22
    s_call_b64 s[60:61], ATT_poll
    s_waitcnt vmcnt(0)
Lfin_22:
    s_mov_b32 s100, 0
    s_branch PV2
L_fin:
L_end:
    s_endpgm
HND:
    s_cmp_eq_u32 s37, 0
    s_cbranch_scc1 HND_act
    s_sub_u32 s37, s37, 1
    s_bitcmp1_b32 s36, 0
    s_cbranch_scc1 HND_ret
    s_cmp_eq_u32 s36, 0
    s_cbranch_scc1 HND_ret
    s_cmp_eq_u32 s36, 2
    s_cbranch_scc1 HND_ret
    s_cmp_ge_u32 s37, s40
    s_cbranch_scc1 HND_ret
    s_waitcnt vmcnt(2)
    s_setpc_b64 s[0:1]
HND_act:
    s_cmp_eq_u32 s36, 8
    s_cbranch_scc1 HND_ret
    s_cmp_eq_u32 s36, 10
    s_cbranch_scc1 H_Q1I
    s_cmp_eq_u32 s36, 9
    s_cbranch_scc1 H_Q1C
    s_cmp_eq_u32 s36, 1
    s_cbranch_scc1 H_WOC
    s_cmp_eq_u32 s36, 2
    s_cbranch_scc1 H_H3I
    s_cmp_eq_u32 s36, 3
    s_cbranch_scc1 H_H3C
    s_cmp_eq_u32 s36, 4
    s_cbranch_scc1 H_QPI
    s_cmp_eq_u32 s36, 5
    s_cbranch_scc1 H_QPC
    s_cmp_eq_u32 s36, 6
    s_cbranch_scc1 H_ATI0
    s_cmp_eq_u32 s36, 7
    s_cbranch_scc1 H_ATC
    s_cmp_eq_u32 s36, 11
    s_cbranch_scc1 H_ALC
H_WOI:
    buffer_load_dwordx4 v[80:83], v18, s[52:55], s80 offen sc1
    buffer_load_dwordx4 v[64:67], v6, s[52:55], s79 offen offset:0 sc1
    buffer_load_dwordx4 v[68:71], v6, s[52:55], s79 offen offset:1024 sc1
    buffer_load_dwordx4 v[72:75], v6, s[52:55], s79 offen offset:2048 sc1
    buffer_load_dwordx4 v[76:79], v6, s[52:55], s79 offen offset:3072 sc1
    s_mov_b32 s36, 1
    s_mov_b32 s37, 2
    s_setpc_b64 s[0:1]
H_WOC:
    s_waitcnt vmcnt(6)
    v_max3_u32 v20, v80, v81, v82
    v_max_u32 v20, v20, v83
    v_max3_u32 v20, v20, v64, v65
    v_max3_u32 v20, v20, v66, v67
    v_max3_u32 v20, v20, v68, v69
    v_max3_u32 v20, v20, v70, v71
    v_max3_u32 v20, v20, v72, v73
    v_max3_u32 v20, v20, v74, v75
    v_max3_u32 v20, v20, v76, v77
    v_max3_u32 v20, v20, v78, v79
    v_cmp_eq_u32 vcc, s11, v20
    s_cbranch_vccnz H_WOI
    s_cmp_eq_u32 s39, 0
    s_cbranch_scc1 HND_ret
    s_waitcnt lgkmcnt(0)
G2_chk:
    v_cmp_eq_u32 vcc, 0, v27
    s_cbranch_vccz G2_ok
    s_cmp_eq_u32 s74, 0
    s_cbranch_scc1 G2_ok
    s_sub_u32 s74, s74, 1
    s_sleep 4
    global_load_dword v27, v26, s[30:31] offset:128 sc1
    s_waitcnt vmcnt(0)
    s_branch G2_chk
G2_ok:
    v_permlane32_swap_b32 v83, v84
    v_add_f32 v80, v80, v81
    v_add_f32 v82, v82, v83
    v_max_f32_dpp v85, v84, v84 quad_perm:[1,0,3,2] row_mask:0xf bank_mask:0xf
    v_add_f32 v80, v80, v82
    v_and_b32 v21, 48, v0
    v_max_f32_dpp v85, v85, v85 quad_perm:[2,3,0,1] row_mask:0xf bank_mask:0xf
    v_sub_f32 v86, v84, v85
    v_exp_f32 v86, v86
    s_mul_i32 s72, s3, 1020
    v_mul_f32 v80, v80, v86
    v_subrev_u32 v22, s72, v6
    s_nop 0
    v_add_f32_dpp v80, v80, v80 quad_perm:[1,0,3,2] row_mask:0xf bank_mask:0xf
    s_nop 1
    v_add_f32_dpp v80, v80, v80 quad_perm:[2,3,0,1] row_mask:0xf bank_mask:0xf
    v_rcp_f32 v80, v80
    s_nop 0
    v_mul_f32 v86, v86, v80
    ds_bpermute_b32 v88, v21, v86 offset:0
    ds_bpermute_b32 v89, v21, v86 offset:4
    ds_bpermute_b32 v90, v21, v86 offset:8
    ds_bpermute_b32 v91, v21, v86 offset:12
    ds_bpermute_b32 v92, v21, v86 offset:64
    ds_bpermute_b32 v93, v21, v86 offset:68
    ds_bpermute_b32 v94, v21, v86 offset:72
    ds_bpermute_b32 v95, v21, v86 offset:76
    s_call_b64 s[60:61], WO_go2
    s_cmp_lg_u32 s3, 3
    s_cbranch_scc1 Lnw_23
    s_mul_i32 s72, s4, 53376
    s_mul_i32 s73, s5, 384
    s_add_u32 s72, s72, s73
    s_add_u32 s72, s72, 1091712
    v_lshlrev_b32 v29, 7, v0
    s_mov_b64 exec, 7
    buffer_load_dword v28, v29, s[52:55], s72 offen sc1
    s_mov_b64 exec, -1
Lnw_23:
    s_mov_b32 s36, 2
    s_mov_b32 s37, 2
    s_setpc_b64 s[0:1]
H_H3I:
    buffer_load_dwordx4 v[64:67], v6, s[52:55], s82 offen sc1
    buffer_load_dwordx4 v[68:71], v6, s[52:55], s82 offen offset:1024 sc1
    s_mov_b32 s36, 3
    s_mov_b32 s37, 2
    s_setpc_b64 s[0:1]
H_H3C:
    s_waitcnt vmcnt(6)
    v_max3_u32 v20, v64, v65, v66
    v_max_u32 v20, v20, v67
    v_max3_u32 v20, v20, v68, v69
    v_max3_u32 v20, v20, v70, v71
    v_cmp_eq_u32 vcc, s11, v20
    s_cbranch_vccnz H_H3I
    s_call_b64 s[60:61], H3_h0
    s_cmp_lg_u32 s3, 3
    s_cbranch_scc1 Lnw_24
    s_mul_i32 s72, s4, 53376
    s_mul_i32 s73, s5, 384
    s_add_u32 s72, s72, s73
    s_add_u32 s72, s72, 1704960
    v_lshlrev_b32 v29, 7, v0
    s_mov_b64 exec, 7
    buffer_load_dword v28, v29, s[52:55], s72 offen sc1
    s_mov_b64 exec, -1
Lnw_24:
    s_cmp_eq_u32 s19, 1
    s_cselect_b32 s36, 4, 6
    s_cselect_b32 s37, 2, 6
    s_setpc_b64 s[0:1]
H_QPI:
H_QPB:
    s_call_b64 s[60:61], QP_first
    s_mov_b32 s40, 0
    s_mov_b32 s36, 6
    s_mov_b32 s37, 3
    s_setpc_b64 s[0:1]
H_QPIz:
    s_waitcnt vmcnt(4)
    s_mov_b32 s37, 3
    s_mov_b32 s12, 0
    s_branch H_QPIzx
H_QPIzr:
    s_waitcnt vmcnt(2)
    s_mov_b32 s37, 0
    s_mov_b32 s12, 1
H_QPIzx:
    v_lshlrev_b32 v49, 3, v0
    v_mov_b64 v[26:27], 0
    s_add_u32 s13, s84, 4096
    buffer_load_dwordx4 v[64:67], v6, s[52:55], s84 offen offset:0 sc1
    buffer_load_dwordx4 v[68:71], v6, s[52:55], s84 offen offset:1024 sc1
    buffer_load_dwordx4 v[72:75], v6, s[52:55], s84 offen offset:2048 sc1
    buffer_load_dwordx4 v[76:79], v6, s[52:55], s84 offen offset:3072 sc1
    buffer_load_dwordx4 v[80:83], v6, s[52:55], s13 offen offset:0 sc1
    buffer_load_dwordx4 v[84:87], v6, s[52:55], s13 offen offset:1024 sc1
    buffer_load_dwordx4 v[88:91], v6, s[52:55], s13 offen offset:2048 sc1
    buffer_load_dwordx2 v[20:21], v49, s[52:55], s91 offen offset:0 sc1
    buffer_load_dwordx2 v[22:23], v49, s[52:55], s91 offen offset:512 sc1
    buffer_load_dwordx2 v[24:25], v49, s[52:55], s91 offen offset:1024 sc1
    s_mov_b32 exec_hi, 0
    buffer_load_dwordx2 v[26:27], v49, s[52:55], s91 offen offset:1536 sc1
    s_mov_b32 exec_hi, -1
    s_mov_b32 s36, 5
    s_setpc_b64 s[0:1]
H_QPC:
    s_waitcnt vmcnt(8)
    s_cmp_eq_u32 s12, 0
    s_cbranch_scc1 Lw_25
    s_waitcnt vmcnt(2)
Lw_25:
    v_max3_u32 v48, v64, v65, v66
    v_max_u32 v48, v48, v67
    v_max3_u32 v48, v48, v68, v69
    v_max3_u32 v48, v48, v70, v71
    v_max3_u32 v48, v48, v72, v73
    v_max3_u32 v48, v48, v74, v75
    v_max3_u32 v48, v48, v76, v77
    v_max3_u32 v48, v48, v78, v79
    v_max3_u32 v48, v48, v80, v81
    v_max3_u32 v48, v48, v82, v83
    v_max3_u32 v48, v48, v84, v85
    v_max3_u32 v48, v48, v86, v87
    v_max3_u32 v48, v48, v88, v89
    v_max3_u32 v48, v48, v90, v91
    v_max3_u32 v48, v48, v20, v21
    v_max3_u32 v48, v48, v22, v23
    v_max3_u32 v48, v48, v24, v25
    v_max3_u32 v48, v48, v26, v27
    v_cmp_eq_u32 vcc, s11, v48
    s_cbranch_vccnz H_QPIzr
    ds_read_b64_tr_b16 v[32:33], v15 offset:0
    ds_read_b64_tr_b16 v[34:35], v15 offset:256
    ds_read_b64_tr_b16 v[36:37], v15 offset:14336
    ds_read_b64_tr_b16 v[38:39], v15 offset:14592
    ds_read_b64_tr_b16 v[40:41], v15 offset:2048
    ds_read_b64_tr_b16 v[42:43], v15 offset:2304
    ds_read_b64_tr_b16 v[44:45], v15 offset:16384
    ds_read_b64_tr_b16 v[46:47], v15 offset:16640
    ds_read_b64_tr_b16 v[56:57], v15 offset:4096
    ds_read_b64_tr_b16 v[58:59], v15 offset:4352
    ds_read_b64_tr_b16 v[60:61], v15 offset:18432
    ds_read_b64_tr_b16 v[62:63], v15 offset:18688
    ds_read_b64_tr_b16 v[92:93], v15 offset:6144
    ds_read_b64_tr_b16 v[94:95], v15 offset:6400
    s_call_b64 s[60:61], QP_go
    s_mov_b32 s36, 6
    s_mov_b32 s37, 0
    s_setpc_b64 s[0:1]
H_ATI0:
    s_cmp_eq_u32 s38, 0
    s_cbranch_scc1 HND_ret
    s_cmp_eq_u32 s41, 0
    s_cbranch_scc1 H_ATI
H_ALI:
    buffer_load_dwordx4 v[32:35], v6, s[52:55], s76 offen sc1
    s_mov_b32 s36, 11
    s_mov_b32 s37, 2
    s_setpc_b64 s[0:1]
H_ALC:
    s_waitcnt vmcnt(6)
    v_max3_u32 v20, v32, v33, v34
    v_max_u32 v20, v20, v35
    v_cmp_eq_u32 vcc, s11, v20
    s_cbranch_vccnz H_ALI
    s_branch H_ATG
H_ATI:
    s_waitcnt vmcnt(4)
    s_mov_b32 s37, 3
    s_mov_b32 s12, 0
    s_branch H_ATIx
H_ATIr:
    s_waitcnt vmcnt(2)
    s_mov_b32 s37, 0
    s_mov_b32 s12, 1
H_ATIx:
    buffer_load_dwordx4 v[32:35], v6, s[52:55], s76 offen sc1
    s_mov_b32 s36, 7
    s_setpc_b64 s[0:1]
H_ATC:
    s_waitcnt vmcnt(8)
    s_cmp_eq_u32 s12, 0
    s_cbranch_scc1 Lw_26
    s_waitcnt vmcnt(2)
Lw_26:
    v_max3_u32 v20, v32, v33, v34
    v_max_u32 v20, v20, v35
    v_cmp_eq_u32 vcc, s11, v20
    s_cbranch_vccnz H_ATIr
H_ATG:
    s_cmp_lt_u32 s38, 2
    s_cbranch_scc1 HND_ret
    s_waitcnt lgkmcnt(0)
    s_call_b64 s[60:61], ATT_h0
    s_mov_b32 s36, 8
HND_ret:
    s_setpc_b64 s[0:1]
H_Q1C:
    s_waitcnt vmcnt(8)
    v_max3_u32 v20, v32, v33, v34
    v_max_u32 v20, v20, v35
    v_max_u32 v20, v20, v27
    v_cmp_eq_u32 vcc, s11, v20
    s_cbranch_vccz Q1_go
H_Q1I:
    v_lshrrev_b32 v25, 1, v0
    v_lshlrev_b32 v25, 8, v25
    v_and_b32 v26, 1, v0
    v_lshl_add_u32 v25, v26, 4, v25
    s_mul_i32 s13, s4, 53376
    s_lshl_b32 s73, s6, 5
    s_add_u32 s13, s13, s73
    s_add_u32 s13, s13, 1048576
    buffer_load_dwordx4 v[32:35], v25, s[52:55], s13 offen sc1
    v_and_b32 v26, 31, v0
    v_lshlrev_b32 v26, 7, v26
    s_lshl_b32 s13, s4, 12
    s_add_u32 s13, s13, 3674112
    buffer_load_dword v27, v26, s[52:55], s13 offen sc1
    s_mov_b32 s36, 9
    s_mov_b32 s37, 3
    s_setpc_b64 s[0:1]
Q1_poll:
    v_lshrrev_b32 v25, 1, v0
    v_lshlrev_b32 v25, 8, v25
    v_and_b32 v26, 1, v0
    v_lshl_add_u32 v25, v26, 4, v25
    s_mul_i32 s13, s4, 53376
    s_lshl_b32 s73, s6, 5
    s_add_u32 s13, s13, s73
    s_add_u32 s13, s13, 1048576
    buffer_load_dwordx4 v[32:35], v25, s[52:55], s13 offen sc1
    v_and_b32 v26, 31, v0
    v_lshlrev_b32 v26, 7, v26
    s_lshl_b32 s13, s4, 12
    s_add_u32 s13, s13, 3674112
    buffer_load_dword v27, v26, s[52:55], s13 offen sc1
    s_waitcnt vmcnt(0)
    v_max3_u32 v20, v32, v33, v34
    v_max_u32 v20, v20, v35
    v_max_u32 v20, v20, v27
    v_cmp_eq_u32 vcc, s11, v20
    s_cbranch_vccz Q1_go
    s_cmp_eq_u32 s74, 0
    s_cbranch_scc1 Q1_go
    s_sub_u32 s74, s74, 1
    s_branch Q1_poll
Q1_go:
    v_readfirstlane_b32 s72, v27
    s_nop 1
    v_cmp_ne_u32 vcc, s72, v27
    s_cbranch_vccnz XC_slow
    s_mov_b32 s22, 3706880
    s_mov_b32 s94, 0
XC_slow:
    s_cmp_lg_u32 s3, 2
    s_cbranch_scc1 Lw0_27
    s_cmp_ge_u32 s5, 28
    s_cbranch_scc1 Lw0_27
    s_mul_i32 s72, s4, 53376
    s_add_u32 s72, s72, 1048576
    s_sub_u32 s72, s72, s63
    s_add_u32 s72, s72, 656384
    s_mul_i32 s73, s5, 1872
    s_add_u32 s72, s72, s73
    buffer_store_dwordx4 v[44:47], v6, s[20:23], s72 offen
    buffer_store_dwordx4 v[44:47], v6, s[92:95], s72 offen  sc1
    s_mov_b32 exec_hi, 0x1fffff
    buffer_store_dwordx4 v[44:47], v6, s[20:23], s72 offen offset:1024
    buffer_store_dwordx4 v[44:47], v6, s[92:95], s72 offen offset:1024 sc1
    s_mov_b32 exec_hi, -1
Lw0_27:
    s_cmp_lg_u32 s5, 31
    s_cbranch_scc1 Lna_28
    s_cmp_lg_u32 s3, 0
    s_cbranch_scc1 Lna_28
    s_lshl_b32 s72, s4, 2
    v_mov_b32 v26, s72
    v_mov_b32 v27, 1
    s_mov_b64 exec, 1
    global_store_dword v26, v27, s[30:31] offset:128 sc1
    s_mov_b64 exec, -1
Lna_28:
    s_cmp_lg_u32 s3, 3
    s_cbranch_scc1 Lnw_29
    s_mul_i32 s72, s4, 53376
    s_mul_i32 s73, s5, 1152
    s_add_u32 s72, s72, s73
    s_add_u32 s72, s72, 1056896
    v_lshlrev_b32 v29, 7, v0
    s_mov_b64 exec, 511
    buffer_load_dword v28, v29, s[52:55], s72 offen sc1
    s_mov_b64 exec, -1
Lnw_29:
    s_waitcnt lgkmcnt(0)
    s_call_b64 s[60:61], ATT_h0
    s_mov_b32 s36, 8
    s_setpc_b64 s[0:1]
PV2:
    s_barrier
    s_mov_b64 exec, s[86:87]
    ds_read_b128 v[80:83], v9 offset:0
    ds_read_b128 v[84:87], v9 offset:32
    ds_read_b128 v[88:91], v9 offset:64
    ds_read_b128 v[92:95], v9 offset:96
    s_mov_b64 exec, -1
    ds_read_b64 v[26:27], v25 offset:256
    ds_read_b64 v[64:65], v23 offset:256
    ds_read_b64 v[66:67], v23 offset:1280
    ds_read_b64 v[68:69], v23 offset:2304
    ds_read_b64 v[70:71], v23 offset:3328
    s_mov_b32 vcc_lo, 0xaaaaaaaa
    s_mov_b32 vcc_hi, 0xaaaaaaaa
    v_xor_b32 v4, 32, v5
    v_xor_b32 v2, 64, v5
    v_xor_b32 v3, 96, v5
    ds_read_b64_tr_b16 v[32:33], v5 offset:0
    ds_read_b64_tr_b16 v[34:35], v5 offset:512
    ds_read_b64_tr_b16 v[36:37], v5 offset:2048
    ds_read_b64_tr_b16 v[38:39], v5 offset:2560
    ds_read_b64_tr_b16 v[40:41], v4 offset:0
    ds_read_b64_tr_b16 v[42:43], v4 offset:512
    ds_read_b64_tr_b16 v[44:45], v4 offset:2048
    ds_read_b64_tr_b16 v[46:47], v4 offset:2560
    v_add_f32_dpp v20, v20, v20 row_ror:8 row_mask:0xf bank_mask:0xf
    v_mov_b64 v[48:49], 0
    v_mov_b64 v[50:51], 0
    v_add_f32_dpp v20, v20, v20 row_ror:4 row_mask:0xf bank_mask:0xf
    v_mov_b64 v[52:53], 0
    v_mov_b64 v[54:55], 0
    v_add_f32_dpp v20, v20, v20 row_ror:2 row_mask:0xf bank_mask:0xf
    v_mov_b64 v[56:57], 0
    v_mov_b64 v[58:59], 0
    v_add_f32_dpp v20, v20, v20 row_ror:1 row_mask:0xf bank_mask:0xf
    v_mov_b64 v[60:61], 0
    v_mov_b64 v[62:63], 0
    s_waitcnt lgkmcnt(8)
    v_max3_f32 v72, v64, v66, v68
    v_max3_f32 v73, v65, v67, v69
    v_max_f32 v72, v72, v70
    v_max_f32 v73, v73, v71
    v_pk_add_f32 v[26:27], v[26:27], v[72:73] neg_lo:[0,1] neg_hi:[0,1]
    v_exp_f32 v26, v26
    v_exp_f32 v27, v27
    v_mov_b32_dpp v72, v73 quad_perm:[0,1,2,3] row_mask:0xc bank_mask:0xf
    v_sub_f32 v22, v24, v72
    v_exp_f32 v22, v22
    v_lshrrev_b32 v23, 5, v0
    v_mul_f32 v20, v20, v22
    v_lshlrev_b32 v23, 10, v23
    v_and_b32 v22, 1, v0
    v_cndmask_b32 v20, v20, v72, vcc
    v_lshl_add_u32 v22, v22, 4, v23
    v_min_u32 v20, -2, v20
    s_mov_b32 exec_lo, 3
    s_mov_b32 exec_hi, 3
    buffer_store_dword v20, v22, s[20:23], s77 offen
    buffer_store_dword v20, v22, s[92:95], s77 offen  sc1
    s_mov_b64 exec, -1
    ds_read_b64_tr_b16 v[72:73], v2 offset:0
    ds_read_b64_tr_b16 v[74:75], v2 offset:512
    ds_read_b64_tr_b16 v[76:77], v2 offset:2048
    ds_read_b64_tr_b16 v[78:79], v2 offset:2560
    ds_read_b64_tr_b16 v[64:65], v3 offset:0
    ds_read_b64_tr_b16 v[66:67], v3 offset:512
    ds_read_b64_tr_b16 v[68:69], v3 offset:2048
    ds_read_b64_tr_b16 v[70:71], v3 offset:2560
    s_waitcnt lgkmcnt(12)
    v_smfmac_f32_16x16x64_bf16 v[48:51], v[80:83], v[32:39], v17
    ds_read_b64_tr_b16 v[32:33], v5 offset:8192
    ds_read_b64_tr_b16 v[34:35], v5 offset:8704
    ds_read_b64_tr_b16 v[36:37], v5 offset:10240
    ds_read_b64_tr_b16 v[38:39], v5 offset:10752
    s_waitcnt lgkmcnt(12)
    v_smfmac_f32_16x16x64_bf16 v[52:55], v[80:83], v[40:47], v17
    ds_read_b64_tr_b16 v[40:41], v4 offset:8192
    ds_read_b64_tr_b16 v[42:43], v4 offset:8704
    ds_read_b64_tr_b16 v[44:45], v4 offset:10240
    ds_read_b64_tr_b16 v[46:47], v4 offset:10752
    s_waitcnt lgkmcnt(12)
    v_smfmac_f32_16x16x64_bf16 v[56:59], v[80:83], v[72:79], v17
    ds_read_b64_tr_b16 v[72:73], v2 offset:8192
    ds_read_b64_tr_b16 v[74:75], v2 offset:8704
    ds_read_b64_tr_b16 v[76:77], v2 offset:10240
    ds_read_b64_tr_b16 v[78:79], v2 offset:10752
    s_waitcnt lgkmcnt(12)
    v_smfmac_f32_16x16x64_bf16 v[60:63], v[80:83], v[64:71], v17
    ds_read_b64_tr_b16 v[64:65], v3 offset:8192
    ds_read_b64_tr_b16 v[66:67], v3 offset:8704
    ds_read_b64_tr_b16 v[68:69], v3 offset:10240
    ds_read_b64_tr_b16 v[70:71], v3 offset:10752
    s_waitcnt lgkmcnt(12)
    v_smfmac_f32_16x16x64_bf16 v[48:51], v[84:87], v[32:39], v17
    s_waitcnt vmcnt(12)
    ds_read_b64_tr_b16 v[32:33], v5 offset:16384
    ds_read_b64_tr_b16 v[34:35], v5 offset:16896
    ds_read_b64_tr_b16 v[36:37], v5 offset:18432
    ds_read_b64_tr_b16 v[38:39], v5 offset:18944
    s_waitcnt lgkmcnt(12)
    v_smfmac_f32_16x16x64_bf16 v[52:55], v[84:87], v[40:47], v17
    ds_read_b64_tr_b16 v[40:41], v4 offset:16384
    ds_read_b64_tr_b16 v[42:43], v4 offset:16896
    ds_read_b64_tr_b16 v[44:45], v4 offset:18432
    ds_read_b64_tr_b16 v[46:47], v4 offset:18944
    s_waitcnt lgkmcnt(12)
    v_smfmac_f32_16x16x64_bf16 v[56:59], v[84:87], v[72:79], v17
    ds_read_b64_tr_b16 v[72:73], v2 offset:16384
    ds_read_b64_tr_b16 v[74:75], v2 offset:16896
    ds_read_b64_tr_b16 v[76:77], v2 offset:18432
    ds_read_b64_tr_b16 v[78:79], v2 offset:18944
    s_waitcnt lgkmcnt(12)
    v_smfmac_f32_16x16x64_bf16 v[60:63], v[84:87], v[64:71], v17
    ds_read_b64_tr_b16 v[64:65], v3 offset:16384
    ds_read_b64_tr_b16 v[66:67], v3 offset:16896
    ds_read_b64_tr_b16 v[68:69], v3 offset:18432
    ds_read_b64_tr_b16 v[70:71], v3 offset:18944
    s_waitcnt lgkmcnt(12)
    v_smfmac_f32_16x16x64_bf16 v[48:51], v[88:91], v[32:39], v17
    s_waitcnt vmcnt(4)
    ds_read_b64_tr_b16 v[32:33], v5 offset:24576
    ds_read_b64_tr_b16 v[34:35], v5 offset:25088
    ds_read_b64_tr_b16 v[36:37], v5 offset:26624
    ds_read_b64_tr_b16 v[38:39], v5 offset:27136
    s_waitcnt lgkmcnt(12)
    v_smfmac_f32_16x16x64_bf16 v[52:55], v[88:91], v[40:47], v17
    ds_read_b64_tr_b16 v[40:41], v4 offset:24576
    ds_read_b64_tr_b16 v[42:43], v4 offset:25088
    ds_read_b64_tr_b16 v[44:45], v4 offset:26624
    ds_read_b64_tr_b16 v[46:47], v4 offset:27136
    s_waitcnt lgkmcnt(12)
    v_smfmac_f32_16x16x64_bf16 v[56:59], v[88:91], v[72:79], v17
    ds_read_b64_tr_b16 v[72:73], v2 offset:24576
    ds_read_b64_tr_b16 v[74:75], v2 offset:25088
    ds_read_b64_tr_b16 v[76:77], v2 offset:26624
    ds_read_b64_tr_b16 v[78:79], v2 offset:27136
    s_waitcnt lgkmcnt(12)
    v_smfmac_f32_16x16x64_bf16 v[60:63], v[88:91], v[64:71], v17
    ds_read_b64_tr_b16 v[64:65], v3 offset:24576
    ds_read_b64_tr_b16 v[66:67], v3 offset:25088
    ds_read_b64_tr_b16 v[68:69], v3 offset:26624
    ds_read_b64_tr_b16 v[70:71], v3 offset:27136
    s_waitcnt lgkmcnt(12)
    v_smfmac_f32_16x16x64_bf16 v[48:51], v[92:95], v[32:39], v17
    s_waitcnt lgkmcnt(8)
    v_smfmac_f32_16x16x64_bf16 v[52:55], v[92:95], v[40:47], v17
    s_waitcnt lgkmcnt(4)
    v_smfmac_f32_16x16x64_bf16 v[56:59], v[92:95], v[72:79], v17
    s_waitcnt lgkmcnt(0)
    v_smfmac_f32_16x16x64_bf16 v[60:63], v[92:95], v[64:71], v17
    s_branch EPI
LOOP:
    s_cmp_ge_u32 s5, 28
    s_cbranch_scc1 L_skipwo
    buffer_load_dwordx4 v[80:83], v18, s[52:55], s80 offen sc1
    s_cmp_eq_u32 s75, 1
    s_cbranch_scc1 L_wot
    v_swap_b32 v96, v112
    v_swap_b32 v97, v113
    v_swap_b32 v98, v114
    v_swap_b32 v99, v115
    v_swap_b32 v100, v116
    v_swap_b32 v101, v117
    v_swap_b32 v102, v118
    v_swap_b32 v103, v119
    v_swap_b32 v104, v120
    v_swap_b32 v105, v121
    v_swap_b32 v106, v122
    v_swap_b32 v107, v123
    v_swap_b32 v108, v124
    v_swap_b32 v109, v125
    v_swap_b32 v110, v126
    v_swap_b32 v111, v127
    s_branch WO_w
L_wot:
    s_waitcnt vmcnt(5)
    s_call_b64 s[60:61], WOT
    s_branch WO_w
WO_poll:
    buffer_load_dwordx4 v[80:83], v18, s[52:55], s80 offen sc1
WO_w:
    s_waitcnt vmcnt(0)
    v_max3_u32 v20, v80, v81, v82
    v_max_u32 v20, v20, v83
    v_cmp_eq_u32 vcc, s10, v20
    s_cbranch_vccnz WO_r1
WO_sc:
    v_permlane32_swap_b32 v83, v84
    v_add_f32 v80, v80, v81
    v_add_f32 v82, v82, v83
    v_max_f32_dpp v85, v84, v84 quad_perm:[1,0,3,2] row_mask:0xf bank_mask:0xf
    v_add_f32 v80, v80, v82
    v_and_b32 v21, 48, v0
    v_max_f32_dpp v85, v85, v85 quad_perm:[2,3,0,1] row_mask:0xf bank_mask:0xf
    v_sub_f32 v86, v84, v85
    v_exp_f32 v86, v86
    buffer_load_dwordx4 v[64:67], v6, s[52:55], s79 offen offset:0 sc1
    buffer_load_dwordx4 v[68:71], v6, s[52:55], s79 offen offset:1024 sc1
    buffer_load_dwordx4 v[72:75], v6, s[52:55], s79 offen offset:2048 sc1
    buffer_load_dwordx4 v[76:79], v6, s[52:55], s79 offen offset:3072 sc1
    s_mul_i32 s72, s3, 1020
    v_mul_f32 v80, v80, v86
    v_subrev_u32 v22, s72, v6
    s_nop 0
    v_add_f32_dpp v80, v80, v80 quad_perm:[1,0,3,2] row_mask:0xf bank_mask:0xf
    s_nop 1
    v_add_f32_dpp v80, v80, v80 quad_perm:[2,3,0,1] row_mask:0xf bank_mask:0xf
    v_rcp_f32 v80, v80
    s_nop 0
    v_mul_f32 v86, v86, v80
    ds_bpermute_b32 v88, v21, v86 offset:0
    ds_bpermute_b32 v89, v21, v86 offset:4
    ds_bpermute_b32 v90, v21, v86 offset:8
    ds_bpermute_b32 v91, v21, v86 offset:12
    ds_bpermute_b32 v92, v21, v86 offset:64
    ds_bpermute_b32 v93, v21, v86 offset:68
    ds_bpermute_b32 v94, v21, v86 offset:72
    ds_bpermute_b32 v95, v21, v86 offset:76
WO_o:
    s_waitcnt vmcnt(3)
    v_max3_u32 v20, v64, v65, v66
    v_max_u32 v20, v20, v67
    s_waitcnt vmcnt(2)
    v_max3_u32 v20, v20, v68, v69
    v_max3_u32 v20, v20, v70, v71
    s_waitcnt vmcnt(1)
    v_max3_u32 v20, v20, v72, v73
    v_max3_u32 v20, v20, v74, v75
    s_waitcnt vmcnt(0)
    v_max3_u32 v20, v20, v76, v77
    v_max3_u32 v20, v20, v78, v79
    v_cmp_eq_u32 vcc, s11, v20
    s_cbranch_vccnz WO_r2
WO_go2:
    v_mfma_f32_16x16x32_bf16 v[48:51], v[64:67], v[96:99], 0
    v_mfma_f32_16x16x32_bf16 v[52:55], v[64:67], v[100:103], 0
    v_mfma_f32_16x16x32_bf16 v[48:51], v[68:71], v[104:107], v[48:51]
    v_mfma_f32_16x16x32_bf16 v[52:55], v[68:71], v[108:111], v[52:55]
    v_mfma_f32_16x16x32_bf16 v[56:59], v[72:75], v[96:99], 0
    v_mfma_f32_16x16x32_bf16 v[60:63], v[72:75], v[100:103], 0
    v_mfma_f32_16x16x32_bf16 v[56:59], v[76:79], v[104:107], v[56:59]
    v_mfma_f32_16x16x32_bf16 v[60:63], v[76:79], v[108:111], v[60:63]
    s_waitcnt lgkmcnt(0)
    s_nop 1
    v_pk_mul_f32 v[48:49], v[48:49], v[88:89]
    s_nop 0
    v_pk_mul_f32 v[52:53], v[52:53], v[88:89]
    v_pk_fma_f32 v[48:49], v[50:51], v[90:91], v[48:49]
    v_pk_fma_f32 v[52:53], v[54:55], v[90:91], v[52:53]
    v_add_f32 v48, v48, v49
    v_add_f32 v52, v52, v53
    ds_write_b32 v22, v48 offset:0
    ds_write_b32 v22, v52 offset:1024
    v_pk_mul_f32 v[56:57], v[56:57], v[92:93]
    v_pk_mul_f32 v[60:61], v[60:61], v[92:93]
    v_pk_fma_f32 v[56:57], v[58:59], v[94:95], v[56:57]
    v_pk_fma_f32 v[60:61], v[62:63], v[94:95], v[60:61]
    v_add_f32 v56, v56, v57
    v_add_f32 v60, v60, v61
    ds_write_b32 v22, v56 offset:2048
    ds_write_b32 v22, v60 offset:3072
    s_waitcnt lgkmcnt(0)
    s_barrier
    ds_read_b128 v[32:35], v6
    s_waitcnt lgkmcnt(0)
    v_pk_add_f32 v[32:33], v[32:33], v[34:35]
    v_add_f32 v32, v32, v33
    v_min_u32 v32, -2, v32
    buffer_store_dword v32, v12, s[52:55], s81 offen sc1
    s_cmp_lg_u32 s100, 0
    s_cbranch_scc1 RET
    s_cmp_eq_u32 s75, 2
    s_cbranch_scc1 L_vpf
    s_cmp_eq_u32 s75, 1
    s_cbranch_scc1 L_h3w
    s_and_b32 s72, s5, 7
    s_cmp_lg_u32 s4, s72
    s_cbranch_scc1 L_fin
L_h3w:
    s_sleep 7
H3_poll:
    buffer_load_dwordx4 v[64:67], v6, s[52:55], s82 offen sc1
    buffer_load_dwordx4 v[68:71], v6, s[52:55], s82 offen offset:1024 sc1
H3_loop:
    s_waitcnt vmcnt(1)
    v_max3_u32 v20, v64, v65, v66
    v_max_u32 v20, v20, v67
    s_waitcnt vmcnt(0)
    v_max3_u32 v20, v20, v68, v69
    v_max3_u32 v20, v20, v70, v71
    v_cmp_eq_u32 vcc, s11, v20
    s_cbranch_vccz H3_h0
    s_sub_u32 s74, s74, 1
    s_cbranch_scc1 Lbud_30
    buffer_load_dwordx4 v[64:67], v6, s[52:55], s82 offen sc1
    buffer_load_dwordx4 v[68:71], v6, s[52:55], s82 offen offset:1024 sc1
    s_branch H3_loop
H3_h0:
    v_pk_add_f32 v[32:33], v[64:65], v[68:69]
    v_pk_add_f32 v[34:35], v[66:67], v[70:71]
H3_go2:
    v_lshlrev_b32 v24, 16, v16
    v_and_b32 v25, 0xffff0000, v16
    v_permlane32_swap_b32 v32, v34
    v_permlane32_swap_b32 v33, v35
    v_pk_add_f32 v[32:33], v[32:33], v[34:35]
    s_cmp_eq_u32 s75, 3
    s_nop 0
    v_add_f32_dpp v32, v32, v32 row_ror:8 row_mask:0xf bank_mask:0xf
    v_add_f32_dpp v33, v33, v33 row_ror:8 row_mask:0xf bank_mask:0xf
    v_mov_b64 v[34:35], v[32:33]
    s_nop 1
    v_permlane16_swap_b32 v32, v34
    v_permlane16_swap_b32 v33, v35
    v_pk_add_f32 v[32:33], v[32:33], v[34:35]
    v_cvt_pk_bf16_f32 v33, v32, v33
    v_lshlrev_b32 v32, 16, v33
    v_and_b32 v33, 0xffff0000, v33
    v_pk_add_f32 v[32:33], v[32:33], v[24:25]
    v_cvt_pk_bf16_f32 v16, v32, v33
    s_mov_b64 exec, s[88:89]
    v_min_u32 v32, -2, v16
    s_cbranch_scc1 H3_final
    buffer_store_dword v32, v13, s[20:23], s83 offen
    buffer_store_dword v32, v13, s[92:95], s83 offen  sc1
    s_mov_b64 exec, -1
    v_lshlrev_b32 v34, 16, v16
    v_and_b32 v35, 0xffff0000, v16
    v_add_f32 v32, v34, v35
    v_mul_f32 v33, v34, v34
    v_fmac_f32 v33, v35, v35
    v_lshrrev_b32 v34, 5, v0
    v_bfe_u32 v35, v0, 2, 1
    v_permlane32_swap_b32 v32, v33
    v_add_f32 v32, v32, v33
    v_lshlrev_b32 v34, 2, v34
    v_lshl_add_u32 v34, v35, 3, v34
    v_add_f32_dpp v32, v32, v32 quad_perm:[1,0,3,2] row_mask:0xf bank_mask:0xf
    s_mov_b32 vcc_lo, 0x11
    s_mov_b32 vcc_hi, 0x11
    v_add_f32_dpp v32, v32, v32 quad_perm:[2,3,0,1] row_mask:0xf bank_mask:0xf
    s_mov_b64 exec, vcc
    v_min_u32 v32, -2, v32
    buffer_store_dword v32, v34, s[20:23], s90 offen
    buffer_store_dword v32, v34, s[92:95], s90 offen  sc1
    s_mov_b64 exec, -1
ADV:
    s_add_u32 s76, s76, 656384
    s_add_u32 s77, s77, 656384
    s_add_u32 s78, s78, 656384
    s_add_u32 s79, s79, 656384
    s_add_u32 s80, s80, 656384
    s_add_u32 s81, s81, 656384
    s_add_u32 s82, s82, 656384
    s_add_u32 s83, s83, 656384
    s_add_u32 s84, s84, 656384
    s_add_u32 s85, s85, 656384
    s_add_u32 s90, s90, 656384
    s_add_u32 s91, s91, 656384
    s_add_u32 s75, s75, 1
    s_cmp_lg_u32 s100, 0
    s_cbranch_scc1 RET
    s_and_b32 s72, s75, 1
    s_cmp_lg_u32 s72, s19
    s_cbranch_scc1 ATT_poll
QP_first:
    v_lshlrev_b32 v49, 3, v0
    v_mov_b64 v[26:27], 0
    s_add_u32 s13, s84, 4096
    buffer_load_dwordx4 v[64:67], v6, s[52:55], s84 offen offset:0 sc1
    buffer_load_dwordx4 v[68:71], v6, s[52:55], s84 offen offset:1024 sc1
    buffer_load_dwordx4 v[72:75], v6, s[52:55], s84 offen offset:2048 sc1
    buffer_load_dwordx4 v[76:79], v6, s[52:55], s84 offen offset:3072 sc1
    buffer_load_dwordx4 v[80:83], v6, s[52:55], s13 offen offset:0 sc1
    buffer_load_dwordx4 v[84:87], v6, s[52:55], s13 offen offset:1024 sc1
    buffer_load_dwordx4 v[88:91], v6, s[52:55], s13 offen offset:2048 sc1
    buffer_load_dwordx2 v[20:21], v49, s[52:55], s91 offen offset:0 sc1
    buffer_load_dwordx2 v[22:23], v49, s[52:55], s91 offen offset:512 sc1
    buffer_load_dwordx2 v[24:25], v49, s[52:55], s91 offen offset:1024 sc1
    s_mov_b32 exec_hi, 0
    buffer_load_dwordx2 v[26:27], v49, s[52:55], s91 offen offset:1536 sc1
    s_mov_b32 exec_hi, -1
    ds_read_b64_tr_b16 v[32:33], v15 offset:0
    ds_read_b64_tr_b16 v[34:35], v15 offset:256
    ds_read_b64_tr_b16 v[36:37], v15 offset:14336
    ds_read_b64_tr_b16 v[38:39], v15 offset:14592
    ds_read_b64_tr_b16 v[40:41], v15 offset:2048
    ds_read_b64_tr_b16 v[42:43], v15 offset:2304
    ds_read_b64_tr_b16 v[44:45], v15 offset:16384
    ds_read_b64_tr_b16 v[46:47], v15 offset:16640
    ds_read_b64_tr_b16 v[56:57], v15 offset:4096
    ds_read_b64_tr_b16 v[58:59], v15 offset:4352
    ds_read_b64_tr_b16 v[60:61], v15 offset:18432
    ds_read_b64_tr_b16 v[62:63], v15 offset:18688
    ds_read_b64_tr_b16 v[92:93], v15 offset:6144
    ds_read_b64_tr_b16 v[94:95], v15 offset:6400
QP_chk:
    s_waitcnt vmcnt(10)
    v_max3_u32 v48, v64, v65, v66
    v_max_u32 v48, v48, v67
    s_waitcnt vmcnt(9)
    v_max3_u32 v48, v48, v68, v69
    v_max3_u32 v48, v48, v70, v71
    s_waitcnt vmcnt(8)
    v_max3_u32 v48, v48, v72, v73
    v_max3_u32 v48, v48, v74, v75
    s_waitcnt vmcnt(7)
    v_max3_u32 v48, v48, v76, v77
    v_max3_u32 v48, v48, v78, v79
    s_waitcnt vmcnt(6)
    v_max3_u32 v48, v48, v80, v81
    v_max3_u32 v48, v48, v82, v83
    s_waitcnt vmcnt(5)
    v_max3_u32 v48, v48, v84, v85
    v_max3_u32 v48, v48, v86, v87
    s_waitcnt vmcnt(4)
    v_max3_u32 v48, v48, v88, v89
    v_max3_u32 v48, v48, v90, v91
    v_cmp_eq_u32 vcc, s11, v48
    s_cbranch_vccnz QP_r
QP_chk2:
    s_waitcnt vmcnt(2)
    v_max3_u32 v48, v20, v21, v22
    v_max_u32 v48, v48, v23
    s_waitcnt vmcnt(0)
    v_max3_u32 v48, v48, v24, v25
    v_max3_u32 v48, v48, v26, v27
    v_cmp_eq_u32 vcc, s11, v48
    s_cbranch_vccnz QP_r2
QP_go:
    s_waitcnt lgkmcnt(0)
    v_mfma_f32_16x16x32_bf16 v[48:51], v[32:35], v[64:67], 0
    ds_read_b64_tr_b16 v[32:33], v15 offset:20480
    ds_read_b64_tr_b16 v[34:35], v15 offset:20736
    v_pk_add_f32 v[20:21], v[20:21], v[22:23]
    v_mfma_f32_16x16x32_bf16 v[52:55], v[36:39], v[64:67], 0
    ds_read_b64_tr_b16 v[36:37], v15 offset:8192
    ds_read_b64_tr_b16 v[38:39], v15 offset:8448
    v_pk_add_f32 v[24:25], v[24:25], v[26:27]
    v_mfma_f32_16x16x32_bf16 v[48:51], v[40:43], v[68:71], v[48:51]
    ds_read_b64_tr_b16 v[40:41], v15 offset:22528
    ds_read_b64_tr_b16 v[42:43], v15 offset:22784
    v_pk_add_f32 v[20:21], v[20:21], v[24:25]
    v_mfma_f32_16x16x32_bf16 v[52:55], v[44:47], v[68:71], v[52:55]
    ds_read_b64_tr_b16 v[44:45], v15 offset:10240
    ds_read_b64_tr_b16 v[46:47], v15 offset:10496
    v_permlane32_swap_b32 v20, v21
    v_mfma_f32_16x16x32_bf16 v[48:51], v[56:59], v[72:75], v[48:51]
    ds_read_b64_tr_b16 v[56:57], v15 offset:24576
    ds_read_b64_tr_b16 v[58:59], v15 offset:24832
    v_add_f32 v20, v20, v21
    v_mfma_f32_16x16x32_bf16 v[52:55], v[60:63], v[72:75], v[52:55]
    ds_read_b64_tr_b16 v[60:61], v15 offset:12288
    ds_read_b64_tr_b16 v[62:63], v15 offset:12544
    v_mov_b32 v21, v20
    v_mfma_f32_16x16x32_bf16 v[48:51], v[92:95], v[76:79], v[48:51]
    ds_read_b64_tr_b16 v[92:93], v15 offset:26624
    ds_read_b64_tr_b16 v[94:95], v15 offset:26880
    v_permlane16_swap_b32 v20, v21
    s_waitcnt lgkmcnt(12)
    v_mfma_f32_16x16x32_bf16 v[52:55], v[32:35], v[76:79], v[52:55]
    v_add_f32 v20, v20, v21
    s_nop 0
    s_waitcnt lgkmcnt(10)
    v_mfma_f32_16x16x32_bf16 v[48:51], v[36:39], v[80:83], v[48:51]
    v_add_f32_dpp v20, v20, v20 row_ror:8 row_mask:0xf bank_mask:0xf
    v_mul_f32 v20, 0x3b124925, v20
    s_waitcnt lgkmcnt(8)
    v_mfma_f32_16x16x32_bf16 v[52:55], v[40:43], v[80:83], v[52:55]
    v_mov_b32 v21, v20
    s_nop 0
    s_waitcnt lgkmcnt(6)
    v_mfma_f32_16x16x32_bf16 v[48:51], v[44:47], v[84:87], v[48:51]
    v_permlane32_swap_b32 v20, v21
    v_fma_f32 v21, -v20, v20, v21
    s_waitcnt lgkmcnt(4)
    v_mfma_f32_16x16x32_bf16 v[52:55], v[56:59], v[84:87], v[52:55]
    v_max_f32 v21, 0, v21
    v_add_f32 v21, 0x3727c5ac, v21
    s_waitcnt lgkmcnt(2)
    v_mfma_f32_16x16x32_bf16 v[48:51], v[60:63], v[88:91], v[48:51]
    v_rsq_f32 v21, v21
    s_nop 0
    s_waitcnt lgkmcnt(0)
    v_mfma_f32_16x16x32_bf16 v[52:55], v[92:95], v[88:91], v[52:55]
    v_mul_f32 v20, v20, v21
    v_pk_mul_f32 v[24:25], v[28:29], v[20:21] op_sel_hi:[1,0]
    v_pk_mul_f32 v[26:27], v[30:31], v[20:21] op_sel_hi:[1,0]
    s_nop 4
    v_add_f32_dpp v48, v52, v48 row_ror:8 row_mask:0xf bank_mask:0xf
    v_add_f32_dpp v49, v53, v49 row_ror:8 row_mask:0xf bank_mask:0xf
    v_add_f32_dpp v50, v54, v50 row_ror:8 row_mask:0xf bank_mask:0xf
    v_add_f32_dpp v51, v55, v51 row_ror:8 row_mask:0xf bank_mask:0xf
    v_pk_fma_f32 v[50:51], v[50:51], v[20:21], v[26:27] op_sel:[0,1,0] neg_lo:[0,0,1] neg_hi:[0,0,1]
    v_pk_fma_f32 v[48:49], v[48:49], v[20:21], v[24:25] op_sel:[0,1,0] neg_lo:[0,0,1] neg_hi:[0,0,1]
    v_cvt_pk_bf16_f32 v53, v50, v51
    v_cvt_pk_bf16_f32 v52, v48, v49
    s_nop 0
    v_mov_b32_dpp v52, v53 row_ror:8 row_mask:0xf bank_mask:0xc
    v_min_u32 v52, -2, v52
    buffer_store_dword v52, v11, s[20:23], s85 offen
    buffer_store_dword v52, v11, s[92:95], s85 offen  sc1
    s_cmp_lg_u32 s100, 0
    s_cbranch_scc1 RET
ATT_poll:
    buffer_load_dwordx4 v[32:35], v6, s[52:55], s76 offen sc1
ATT_loop:
    s_waitcnt vmcnt(0)
    v_max3_u32 v20, v32, v33, v34
    v_max_u32 v20, v20, v35
    v_cmp_eq_u32 vcc, s11, v20
    s_cbranch_vccz ATT_h0
    s_sub_u32 s74, s74, 1
    s_cbranch_scc1 Lbud_31
    buffer_load_dwordx4 v[32:35], v6, s[52:55], s76 offen sc1
    s_branch ATT_loop
ATT_h0:
    ds_write_b128 v6, v[32:35]
ATT_go2:
    ds_read_b128 v[64:67], v7 offset:0
    ds_read_b128 v[68:71], v7 offset:128
    ds_read_b128 v[72:75], v7 offset:256
    ds_read_b128 v[76:79], v7 offset:384
    s_bitcmp1_b32 s75, 0
    v_mov_b64 v[48:49], 0
    v_mov_b64 v[50:51], 0
    v_mov_b64 v[52:53], 0
    v_mov_b64 v[54:55], 0
    v_mov_b64 v[56:57], 0
    v_mov_b64 v[58:59], 0
    v_mov_b64 v[60:61], 0
    v_mov_b64 v[62:63], 0
    s_cbranch_scc1 ATT_qkB
    s_waitcnt lgkmcnt(3)
    v_smfmac_f32_16x16x64_bf16 v[48:51], v[64:67], a[0:7], v17
    s_waitcnt lgkmcnt(2)
    v_smfmac_f32_16x16x64_bf16 v[48:51], v[68:71], a[8:15], v17
    s_waitcnt lgkmcnt(1)
    v_smfmac_f32_16x16x64_bf16 v[48:51], v[72:75], a[16:23], v17
    s_waitcnt lgkmcnt(0)
    v_smfmac_f32_16x16x64_bf16 v[48:51], v[76:79], a[24:31], v17
    v_smfmac_f32_16x16x64_bf16 v[52:55], v[64:67], a[32:39], v17
    v_lshrrev_b32 v25, 5, v0
    v_smfmac_f32_16x16x64_bf16 v[52:55], v[68:71], a[40:47], v17
    v_lshlrev_b32 v25, 2, v25
    v_smfmac_f32_16x16x64_bf16 v[52:55], v[72:75], a[48:55], v17
    v_add_u32 v25, s63, v25
    v_smfmac_f32_16x16x64_bf16 v[52:55], v[76:79], a[56:63], v17
    v_smfmac_f32_16x16x64_bf16 v[56:59], v[64:67], a[64:71], v17
    v_smfmac_f32_16x16x64_bf16 v[56:59], v[68:71], a[72:79], v17
    v_smfmac_f32_16x16x64_bf16 v[56:59], v[72:75], a[80:87], v17
    v_smfmac_f32_16x16x64_bf16 v[56:59], v[76:79], a[88:95], v17
    v_add_f32_dpp v20, v48, v50 quad_perm:[0,1,2,3] row_mask:0x1 bank_mask:0xf
    v_smfmac_f32_16x16x64_bf16 v[60:63], v[64:67], a[96:103], v17
    v_add_f32_dpp v21, v49, v51 quad_perm:[0,1,2,3] row_mask:0x1 bank_mask:0xf
    v_smfmac_f32_16x16x64_bf16 v[60:63], v[68:71], a[104:111], v17
    v_smfmac_f32_16x16x64_bf16 v[60:63], v[72:75], a[112:119], v17
    v_smfmac_f32_16x16x64_bf16 v[60:63], v[76:79], a[120:127], v17
    s_branch ATT_sm
ATT_qkB:
    s_waitcnt lgkmcnt(3)
    v_smfmac_f32_16x16x64_bf16 v[48:51], v[64:67], a[128:135], v17
    s_waitcnt lgkmcnt(2)
    v_smfmac_f32_16x16x64_bf16 v[48:51], v[68:71], a[136:143], v17
    s_waitcnt lgkmcnt(1)
    v_smfmac_f32_16x16x64_bf16 v[48:51], v[72:75], a[144:151], v17
    s_waitcnt lgkmcnt(0)
    v_smfmac_f32_16x16x64_bf16 v[48:51], v[76:79], a[152:159], v17
    v_smfmac_f32_16x16x64_bf16 v[52:55], v[64:67], a[160:167], v17
    v_lshrrev_b32 v25, 5, v0
    v_smfmac_f32_16x16x64_bf16 v[52:55], v[68:71], a[168:175], v17
    v_lshlrev_b32 v25, 2, v25
    v_smfmac_f32_16x16x64_bf16 v[52:55], v[72:75], a[176:183], v17
    v_add_u32 v25, s63, v25
    v_smfmac_f32_16x16x64_bf16 v[52:55], v[76:79], a[184:191], v17
    v_smfmac_f32_16x16x64_bf16 v[56:59], v[64:67], a[192:199], v17
    v_smfmac_f32_16x16x64_bf16 v[56:59], v[68:71], a[200:207], v17
    v_smfmac_f32_16x16x64_bf16 v[56:59], v[72:75], a[208:215], v17
    v_smfmac_f32_16x16x64_bf16 v[56:59], v[76:79], a[216:223], v17
    v_add_f32_dpp v20, v48, v50 quad_perm:[0,1,2,3] row_mask:0x1 bank_mask:0xf
    v_smfmac_f32_16x16x64_bf16 v[60:63], v[64:67], a[224:231], v17
    v_add_f32_dpp v21, v49, v51 quad_perm:[0,1,2,3] row_mask:0x1 bank_mask:0xf
    v_smfmac_f32_16x16x64_bf16 v[60:63], v[68:71], a[232:239], v17
    v_smfmac_f32_16x16x64_bf16 v[60:63], v[72:75], a[240:247], v17
    v_smfmac_f32_16x16x64_bf16 v[60:63], v[76:79], a[248:255], v17
ATT_sm:
    v_add_f32_dpp v20, v52, v54 quad_perm:[0,1,2,3] row_mask:0x2 bank_mask:0xf
    v_add_f32_dpp v21, v53, v55 quad_perm:[0,1,2,3] row_mask:0x2 bank_mask:0xf
    v_mov_b64 v[80:81], 0
    v_add_f32_dpp v20, v56, v58 quad_perm:[0,1,2,3] row_mask:0x4 bank_mask:0xf
    v_add_f32_dpp v21, v57, v59 quad_perm:[0,1,2,3] row_mask:0x4 bank_mask:0xf
    v_mov_b64 v[82:83], 0
    v_mov_b64 v[84:85], 0
    v_mov_b64 v[86:87], 0
    v_add_f32_dpp v20, v60, v62 quad_perm:[0,1,2,3] row_mask:0x8 bank_mask:0xf
    v_add_f32_dpp v21, v61, v63 quad_perm:[0,1,2,3] row_mask:0x8 bank_mask:0xf
    v_mov_b64 v[22:23], v[20:21]
    v_mov_b64 v[88:89], 0
    v_mov_b64 v[90:91], 0
    v_permlane32_swap_b32 v22, v23
    v_max_f32 v22, v22, v23
    v_mov_b32 v23, v22
    v_mov_b64 v[92:93], 0
    v_mov_b64 v[94:95], 0
    v_permlane16_swap_b32 v22, v23
    v_max_f32 v22, v22, v23
    s_nop 1
    v_max_f32_dpp v22, v22, v22 row_ror:8 row_mask:0xf bank_mask:0xf
    s_nop 1
    v_max_f32_dpp v22, v22, v22 row_ror:4 row_mask:0xf bank_mask:0xf
    s_nop 1
    v_max_f32_dpp v22, v22, v22 row_ror:2 row_mask:0xf bank_mask:0xf
    s_nop 1
    v_max_f32_dpp v22, v22, v22 row_ror:1 row_mask:0xf bank_mask:0xf
    v_mul_f32 v22, s96, v22
    v_mov_b32 v23, v22
    v_mov_b32 v24, v22
    ds_write_b32 v25, v22 offset:256
    v_permlane32_swap_b32 v22, v23
    v_fma_f32 v20, v20, s96, -v22
    v_fma_f32 v21, v21, s96, -v23
    v_exp_f32 v20, v20
    v_exp_f32 v21, v21
    s_cmp_lg_u32 s100, 0
    v_cvt_pk_bf16_f32 v22, v20, v21
    ds_write_b16 v8, v22
    ds_write_b16_d16_hi v8, v22 offset:128
    v_permlane32_swap_b32 v20, v21
    v_add_f32 v20, v20, v21
    v_mov_b32 v21, v20
    v_and_b32 v25, 0xffffff6f, v9
    v_and_b32 v23, 0xfffff000, v9
    v_permlane16_swap_b32 v20, v21
    v_add_f32 v20, v20, v21
    s_waitcnt lgkmcnt(0)
    s_cbranch_scc1 RET
PV:
    s_barrier
    s_mov_b64 exec, s[86:87]
    ds_read_b128 v[80:83], v9 offset:0
    ds_read_b128 v[84:87], v9 offset:32
    ds_read_b128 v[88:91], v9 offset:64
    ds_read_b128 v[92:95], v9 offset:96
    s_mov_b64 exec, -1
    ds_read_b64 v[26:27], v25 offset:256
    ds_read_b64 v[64:65], v23 offset:256
    ds_read_b64 v[66:67], v23 offset:1280
    ds_read_b64 v[68:69], v23 offset:2304
    ds_read_b64 v[70:71], v23 offset:3328
    v_add_f32_dpp v20, v20, v20 row_ror:8 row_mask:0xf bank_mask:0xf
    v_mov_b64 v[48:49], 0
    v_mov_b64 v[50:51], 0
    v_add_f32_dpp v20, v20, v20 row_ror:4 row_mask:0xf bank_mask:0xf
    v_mov_b64 v[52:53], 0
    v_mov_b64 v[54:55], 0
    v_add_f32_dpp v20, v20, v20 row_ror:2 row_mask:0xf bank_mask:0xf
    v_mov_b64 v[56:57], 0
    v_mov_b64 v[58:59], 0
    v_add_f32_dpp v20, v20, v20 row_ror:1 row_mask:0xf bank_mask:0xf
    v_mov_b64 v[60:61], 0
    v_mov_b64 v[62:63], 0
    s_mov_b32 vcc_lo, 0xaaaaaaaa
    s_mov_b32 vcc_hi, 0xaaaaaaaa
    s_waitcnt lgkmcnt(8)
    v_smfmac_f32_16x16x64_bf16 v[48:51], v[80:83], v[128:135], v17
    v_smfmac_f32_16x16x64_bf16 v[52:55], v[80:83], v[136:143], v17
    v_smfmac_f32_16x16x64_bf16 v[56:59], v[80:83], v[144:151], v17
    s_waitcnt lgkmcnt(0)
    v_smfmac_f32_16x16x64_bf16 v[60:63], v[80:83], v[152:159], v17
    v_max3_f32 v72, v64, v66, v68
    v_smfmac_f32_16x16x64_bf16 v[48:51], v[84:87], v[160:167], v17
    v_max3_f32 v73, v65, v67, v69
    v_max_f32 v72, v72, v70
    v_smfmac_f32_16x16x64_bf16 v[52:55], v[84:87], v[168:175], v17
    v_max_f32 v73, v73, v71
    v_smfmac_f32_16x16x64_bf16 v[56:59], v[84:87], v[176:183], v17
    v_pk_add_f32 v[26:27], v[26:27], v[72:73] neg_lo:[0,1] neg_hi:[0,1]
    v_smfmac_f32_16x16x64_bf16 v[60:63], v[84:87], v[184:191], v17
    v_exp_f32 v26, v26
    v_smfmac_f32_16x16x64_bf16 v[48:51], v[88:91], v[192:199], v17
    v_exp_f32 v27, v27
    v_mov_b32_dpp v72, v73 quad_perm:[0,1,2,3] row_mask:0xc bank_mask:0xf
    v_smfmac_f32_16x16x64_bf16 v[52:55], v[88:91], v[200:207], v17
    v_sub_f32 v22, v24, v72
    v_smfmac_f32_16x16x64_bf16 v[56:59], v[88:91], v[208:215], v17
    v_exp_f32 v22, v22
    v_smfmac_f32_16x16x64_bf16 v[60:63], v[88:91], v[216:223], v17
    v_lshrrev_b32 v23, 5, v0
    v_smfmac_f32_16x16x64_bf16 v[48:51], v[92:95], v[224:231], v17
    v_mul_f32 v20, v20, v22
    v_lshlrev_b32 v23, 10, v23
    v_smfmac_f32_16x16x64_bf16 v[52:55], v[92:95], v[232:239], v17
    v_and_b32 v22, 1, v0
    v_cndmask_b32 v20, v20, v72, vcc
    v_smfmac_f32_16x16x64_bf16 v[56:59], v[92:95], v[240:247], v17
    v_lshl_add_u32 v22, v22, 4, v23
    v_min_u32 v20, -2, v20
    v_smfmac_f32_16x16x64_bf16 v[60:63], v[92:95], v[248:255], v17
    s_mov_b32 exec_lo, 3
    s_mov_b32 exec_hi, 3
    buffer_store_dword v20, v22, s[20:23], s77 offen
    buffer_store_dword v20, v22, s[92:95], s77 offen  sc1
    s_mov_b64 exec, -1
EPI:
    s_nop 4
    v_pk_add_f32 v[48:49], v[48:49], v[50:51]
    v_pk_add_f32 v[52:53], v[52:53], v[54:55]
    v_pk_add_f32 v[56:57], v[56:57], v[58:59]
    v_pk_add_f32 v[60:61], v[60:61], v[62:63]
    v_pk_mul_f32 v[48:49], v[48:49], v[26:27]
    v_pk_mul_f32 v[56:57], v[56:57], v[26:27]
    v_pk_mul_f32 v[52:53], v[52:53], v[26:27]
    v_pk_mul_f32 v[60:61], v[60:61], v[26:27]
    v_permlane32_swap_b32 v48, v56
    v_permlane32_swap_b32 v49, v57
    v_permlane32_swap_b32 v52, v60
    v_permlane32_swap_b32 v53, v61
    v_pk_add_f32 v[48:49], v[48:49], v[56:57]
    v_pk_add_f32 v[52:53], v[52:53], v[60:61]
    s_nop 1
    v_permlane16_swap_b32 v48, v52
    v_permlane16_swap_b32 v49, v53
    v_pk_add_f32 v[48:49], v[48:49], v[52:53]
    v_cndmask_b32 v20, v49, v48, vcc
    s_nop 1
    v_mov_b32_dpp v21, v20 quad_perm:[1,0,3,2] row_mask:0xf bank_mask:0xf
    v_cndmask_b32 v22, v48, v21, vcc
    v_cndmask_b32 v23, v21, v49, vcc
    v_cvt_pk_bf16_f32 v20, v22, v23
    v_min_u32 v20, -2, v20
    buffer_store_dword v20, v10, s[20:23], s78 offen
    buffer_store_dword v20, v10, s[92:95], s78 offen  sc1
    s_cmp_lg_u32 s100, 0
    s_cbranch_scc1 RET
    s_branch LOOP
RET:
    s_setpc_b64 s[60:61]
L_vpf:
    s_call_b64 s[60:61], VC_0
    s_mov_b32 s56, s28
    s_mov_b32 s57, s29
    s_mov_b32 s58, 7168
    s_mov_b32 s59, 0x20000
    s_branch H3_poll
L_skipwo:
    s_cmp_eq_u32 s75, 3
    s_cbranch_scc1 L_fin
    s_cmp_eq_u32 s75, 1
    s_cbranch_scc1 ADV
    s_call_b64 s[60:61], VC_0
    s_branch ADV
WOT:
    v_and_b32 v24, 1, v0
    v_lshlrev_b32 v24, 4, v24
    v_lshlrev_b32 v24, v24, s101
    v_bfe_u32 v25, v0, 3, 1
    v_lshrrev_b32 v26, 4, v0
    v_cmp_eq_u32 vcc, v25, v26
    v_bfe_u32 v25, v0, 1, 2
    s_nop 0
    v_cndmask_b32 v24, 0, v24, vcc
    v_cmp_eq_u32 vcc, 0, v25
    v_cmp_eq_u32 s[34:35], 1, v25
    s_nop 0
    v_cndmask_b32 v20, 0, v24, vcc
    v_cndmask_b32 v21, 0, v24, s[34:35]
    v_cmp_eq_u32 vcc, 2, v25
    v_cmp_eq_u32 s[34:35], 3, v25
    s_nop 0
    v_cndmask_b32 v22, 0, v24, vcc
    v_cndmask_b32 v23, 0, v24, s[34:35]
    v_mov_b64 v[24:25], 0
    v_mov_b64 v[26:27], 0
    v_mfma_f32_16x16x32_bf16 v[48:51], v[112:115], v[20:23], 0
    v_mfma_f32_16x16x32_bf16 v[52:55], v[116:119], v[20:23], 0
    v_mfma_f32_16x16x32_bf16 v[56:59], v[120:123], v[20:23], 0
    v_mfma_f32_16x16x32_bf16 v[60:63], v[124:127], v[20:23], 0
    v_permlane32_swap_b32 v24, v20
    v_permlane32_swap_b32 v25, v21
    v_permlane32_swap_b32 v26, v22
    v_permlane32_swap_b32 v27, v23
    s_nop 1
    v_mfma_f32_16x16x32_bf16 v[32:35], v[112:115], v[24:27], 0
    v_mfma_f32_16x16x32_bf16 v[36:39], v[116:119], v[24:27], 0
    v_mfma_f32_16x16x32_bf16 v[40:43], v[120:123], v[24:27], 0
    v_mfma_f32_16x16x32_bf16 v[44:47], v[124:127], v[24:27], 0
    v_mov_b64 v[112:113], v[96:97]
    v_mov_b64 v[114:115], v[98:99]
    v_mov_b64 v[116:117], v[100:101]
    v_mov_b64 v[118:119], v[102:103]
    v_mov_b64 v[120:121], v[104:105]
    v_mov_b64 v[122:123], v[106:107]
    v_mov_b64 v[124:125], v[108:109]
    v_mov_b64 v[126:127], v[110:111]
    v_cvt_pk_bf16_f32 v96, v48, v49
    v_cvt_pk_bf16_f32 v97, v50, v51
    v_cvt_pk_bf16_f32 v98, v52, v53
    v_cvt_pk_bf16_f32 v99, v54, v55
    v_cvt_pk_bf16_f32 v104, v56, v57
    v_cvt_pk_bf16_f32 v105, v58, v59
    v_cvt_pk_bf16_f32 v106, v60, v61
    v_cvt_pk_bf16_f32 v107, v62, v63
    v_cvt_pk_bf16_f32 v100, v32, v33
    v_cvt_pk_bf16_f32 v101, v34, v35
    v_cvt_pk_bf16_f32 v102, v36, v37
    v_cvt_pk_bf16_f32 v103, v38, v39
    v_cvt_pk_bf16_f32 v108, v40, v41
    v_cvt_pk_bf16_f32 v109, v42, v43
    v_cvt_pk_bf16_f32 v110, v44, v45
    v_cvt_pk_bf16_f32 v111, v46, v47
    s_setpc_b64 s[60:61]
H3_final:
    buffer_store_dword v16, v14, s[56:59], s97 offen
    s_mov_b64 exec, -1
    s_branch L_fin
WO_r1:
    s_sub_u32 s74, s74, 1
    s_cbranch_scc1 Lbud_32
    s_branch WO_poll
WO_r2:
    s_sub_u32 s74, s74, 1
    s_cbranch_scc1 Lbud_33
    buffer_load_dwordx4 v[64:67], v6, s[52:55], s79 offen offset:0 sc1
    buffer_load_dwordx4 v[68:71], v6, s[52:55], s79 offen offset:1024 sc1
    buffer_load_dwordx4 v[72:75], v6, s[52:55], s79 offen offset:2048 sc1
    buffer_load_dwordx4 v[76:79], v6, s[52:55], s79 offen offset:3072 sc1
    s_branch WO_o
QP_r:
    s_sub_u32 s74, s74, 1
    s_cbranch_scc1 Lbud_34
    s_add_u32 s13, s84, 4096
    buffer_load_dwordx4 v[64:67], v6, s[52:55], s84 offen offset:0 sc1
    buffer_load_dwordx4 v[68:71], v6, s[52:55], s84 offen offset:1024 sc1
    buffer_load_dwordx4 v[72:75], v6, s[52:55], s84 offen offset:2048 sc1
    buffer_load_dwordx4 v[76:79], v6, s[52:55], s84 offen offset:3072 sc1
    buffer_load_dwordx4 v[80:83], v6, s[52:55], s13 offen offset:0 sc1
    buffer_load_dwordx4 v[84:87], v6, s[52:55], s13 offen offset:1024 sc1
    buffer_load_dwordx4 v[88:91], v6, s[52:55], s13 offen offset:2048 sc1
    buffer_load_dwordx2 v[20:21], v49, s[52:55], s91 offen offset:0 sc1
    buffer_load_dwordx2 v[22:23], v49, s[52:55], s91 offen offset:512 sc1
    buffer_load_dwordx2 v[24:25], v49, s[52:55], s91 offen offset:1024 sc1
    s_mov_b32 exec_hi, 0
    buffer_load_dwordx2 v[26:27], v49, s[52:55], s91 offen offset:1536 sc1
    s_mov_b32 exec_hi, -1
    s_branch QP_chk
QP_r2:
    s_sub_u32 s74, s74, 1
    s_cbranch_scc1 Lbud_35
    buffer_load_dwordx2 v[20:21], v49, s[52:55], s91 offen offset:0 sc1
    buffer_load_dwordx2 v[22:23], v49, s[52:55], s91 offen offset:512 sc1
    buffer_load_dwordx2 v[24:25], v49, s[52:55], s91 offen offset:1024 sc1
    s_mov_b32 exec_hi, 0
    buffer_load_dwordx2 v[26:27], v49, s[52:55], s91 offen offset:1536 sc1
    s_mov_b32 exec_hi, -1
    s_branch QP_chk2
VC_0:
    v_xor_b32 v21, 32, v5
    v_xor_b32 v22, 64, v5
    v_xor_b32 v23, 96, v5
    ds_read_b64_tr_b16 v[128:129], v5 offset:0
    ds_read_b64_tr_b16 v[130:131], v5 offset:512
    ds_read_b64_tr_b16 v[132:133], v5 offset:2048
    ds_read_b64_tr_b16 v[134:135], v5 offset:2560
    ds_read_b64_tr_b16 v[136:137], v21 offset:0
    ds_read_b64_tr_b16 v[138:139], v21 offset:512
    ds_read_b64_tr_b16 v[140:141], v21 offset:2048
    ds_read_b64_tr_b16 v[142:143], v21 offset:2560
    ds_read_b64_tr_b16 v[144:145], v22 offset:0
    ds_read_b64_tr_b16 v[146:147], v22 offset:512
    ds_read_b64_tr_b16 v[148:149], v22 offset:2048
    ds_read_b64_tr_b16 v[150:151], v22 offset:2560
    ds_read_b64_tr_b16 v[152:153], v23 offset:0
    ds_read_b64_tr_b16 v[154:155], v23 offset:512
    ds_read_b64_tr_b16 v[156:157], v23 offset:2048
    ds_read_b64_tr_b16 v[158:159], v23 offset:2560
    s_cmp_lg_u32 s100, 0
    s_cbranch_scc1 RET
VC_1:
    v_xor_b32 v21, 32, v5
    v_xor_b32 v22, 64, v5
    v_xor_b32 v23, 96, v5
    ds_read_b64_tr_b16 v[160:161], v5 offset:8192
    ds_read_b64_tr_b16 v[162:163], v5 offset:8704
    ds_read_b64_tr_b16 v[164:165], v5 offset:10240
    ds_read_b64_tr_b16 v[166:167], v5 offset:10752
    ds_read_b64_tr_b16 v[168:169], v21 offset:8192
    ds_read_b64_tr_b16 v[170:171], v21 offset:8704
    ds_read_b64_tr_b16 v[172:173], v21 offset:10240
    ds_read_b64_tr_b16 v[174:175], v21 offset:10752
    ds_read_b64_tr_b16 v[176:177], v22 offset:8192
    ds_read_b64_tr_b16 v[178:179], v22 offset:8704
    ds_read_b64_tr_b16 v[180:181], v22 offset:10240
    ds_read_b64_tr_b16 v[182:183], v22 offset:10752
    ds_read_b64_tr_b16 v[184:185], v23 offset:8192
    ds_read_b64_tr_b16 v[186:187], v23 offset:8704
    ds_read_b64_tr_b16 v[188:189], v23 offset:10240
    ds_read_b64_tr_b16 v[190:191], v23 offset:10752
    s_cmp_lg_u32 s100, 0
    s_cbranch_scc1 RET
VC_2:
    v_xor_b32 v21, 32, v5
    v_xor_b32 v22, 64, v5
    v_xor_b32 v23, 96, v5
    ds_read_b64_tr_b16 v[192:193], v5 offset:16384
    ds_read_b64_tr_b16 v[194:195], v5 offset:16896
    ds_read_b64_tr_b16 v[196:197], v5 offset:18432
    ds_read_b64_tr_b16 v[198:199], v5 offset:18944
    ds_read_b64_tr_b16 v[200:201], v21 offset:16384
    ds_read_b64_tr_b16 v[202:203], v21 offset:16896
    ds_read_b64_tr_b16 v[204:205], v21 offset:18432
    ds_read_b64_tr_b16 v[206:207], v21 offset:18944
    ds_read_b64_tr_b16 v[208:209], v22 offset:16384
    ds_read_b64_tr_b16 v[210:211], v22 offset:16896
    ds_read_b64_tr_b16 v[212:213], v22 offset:18432
    ds_read_b64_tr_b16 v[214:215], v22 offset:18944
    ds_read_b64_tr_b16 v[216:217], v23 offset:16384
    ds_read_b64_tr_b16 v[218:219], v23 offset:16896
    ds_read_b64_tr_b16 v[220:221], v23 offset:18432
    ds_read_b64_tr_b16 v[222:223], v23 offset:18944
    s_cmp_lg_u32 s100, 0
    s_cbranch_scc1 RET
VC_3:
    v_xor_b32 v21, 32, v5
    v_xor_b32 v22, 64, v5
    v_xor_b32 v23, 96, v5
    ds_read_b64_tr_b16 v[224:225], v5 offset:24576
    ds_read_b64_tr_b16 v[226:227], v5 offset:25088
    ds_read_b64_tr_b16 v[228:229], v5 offset:26624
    ds_read_b64_tr_b16 v[230:231], v5 offset:27136
    ds_read_b64_tr_b16 v[232:233], v21 offset:24576
    ds_read_b64_tr_b16 v[234:235], v21 offset:25088
    ds_read_b64_tr_b16 v[236:237], v21 offset:26624
    ds_read_b64_tr_b16 v[238:239], v21 offset:27136
    ds_read_b64_tr_b16 v[240:241], v22 offset:24576
    ds_read_b64_tr_b16 v[242:243], v22 offset:25088
    ds_read_b64_tr_b16 v[244:245], v22 offset:26624
    ds_read_b64_tr_b16 v[246:247], v22 offset:27136
    ds_read_b64_tr_b16 v[248:249], v23 offset:24576
    ds_read_b64_tr_b16 v[250:251], v23 offset:25088
    ds_read_b64_tr_b16 v[252:253], v23 offset:26624
    ds_read_b64_tr_b16 v[254:255], v23 offset:27136
    s_setpc_b64 s[60:61]
CSUM:
    v_mov_b32 v20, 1065369472
    v_mov_b32 v21, 1065369472
    v_mov_b32 v22, 1065369472
    v_mov_b32 v23, 1065369472
    ds_read_b64_tr_b16 v[32:33], v15 offset:0
    ds_read_b64_tr_b16 v[34:35], v15 offset:256
    ds_read_b64_tr_b16 v[36:37], v15 offset:2048
    ds_read_b64_tr_b16 v[38:39], v15 offset:2304
    ds_read_b64_tr_b16 v[40:41], v15 offset:4096
    ds_read_b64_tr_b16 v[42:43], v15 offset:4352
    ds_read_b64_tr_b16 v[44:45], v15 offset:6144
    ds_read_b64_tr_b16 v[46:47], v15 offset:6400
    s_waitcnt lgkmcnt(6)
    v_mfma_f32_16x16x32_bf16 v[28:31], v[32:35], v[20:23], 0
    ds_read_b64_tr_b16 v[32:33], v15 offset:8192
    ds_read_b64_tr_b16 v[34:35], v15 offset:8448
    s_waitcnt lgkmcnt(6)
    v_mfma_f32_16x16x32_bf16 v[28:31], v[36:39], v[20:23], v[28:31]
    ds_read_b64_tr_b16 v[36:37], v15 offset:10240
    ds_read_b64_tr_b16 v[38:39], v15 offset:10496
    s_waitcnt lgkmcnt(6)
    v_mfma_f32_16x16x32_bf16 v[28:31], v[40:43], v[20:23], v[28:31]
    ds_read_b64_tr_b16 v[40:41], v15 offset:12288
    ds_read_b64_tr_b16 v[42:43], v15 offset:12544
    s_waitcnt lgkmcnt(6)
    v_mfma_f32_16x16x32_bf16 v[28:31], v[44:47], v[20:23], v[28:31]
    ds_read_b64_tr_b16 v[44:45], v15 offset:14336
    ds_read_b64_tr_b16 v[46:47], v15 offset:14592
    s_waitcnt lgkmcnt(6)
    v_mfma_f32_16x16x32_bf16 v[28:31], v[32:35], v[20:23], v[28:31]
    ds_read_b64_tr_b16 v[32:33], v15 offset:16384
    ds_read_b64_tr_b16 v[34:35], v15 offset:16640
    s_waitcnt lgkmcnt(6)
    v_mfma_f32_16x16x32_bf16 v[28:31], v[36:39], v[20:23], v[28:31]
    ds_read_b64_tr_b16 v[36:37], v15 offset:18432
    ds_read_b64_tr_b16 v[38:39], v15 offset:18688
    s_waitcnt lgkmcnt(6)
    v_mfma_f32_16x16x32_bf16 v[28:31], v[40:43], v[20:23], v[28:31]
    ds_read_b64_tr_b16 v[40:41], v15 offset:20480
    ds_read_b64_tr_b16 v[42:43], v15 offset:20736
    s_waitcnt lgkmcnt(6)
    v_mfma_f32_16x16x32_bf16 v[28:31], v[44:47], v[20:23], v[28:31]
    ds_read_b64_tr_b16 v[44:45], v15 offset:22528
    ds_read_b64_tr_b16 v[46:47], v15 offset:22784
    s_waitcnt lgkmcnt(6)
    v_mfma_f32_16x16x32_bf16 v[28:31], v[32:35], v[20:23], v[28:31]
    ds_read_b64_tr_b16 v[32:33], v15 offset:24576
    ds_read_b64_tr_b16 v[34:35], v15 offset:24832
    s_waitcnt lgkmcnt(6)
    v_mfma_f32_16x16x32_bf16 v[28:31], v[36:39], v[20:23], v[28:31]
    ds_read_b64_tr_b16 v[36:37], v15 offset:26624
    ds_read_b64_tr_b16 v[38:39], v15 offset:26880
    s_waitcnt lgkmcnt(6)
    v_mfma_f32_16x16x32_bf16 v[28:31], v[40:43], v[20:23], v[28:31]
    s_waitcnt lgkmcnt(4)
    v_mfma_f32_16x16x32_bf16 v[28:31], v[44:47], v[20:23], v[28:31]
    s_waitcnt lgkmcnt(2)
    v_mfma_f32_16x16x32_bf16 v[28:31], v[32:35], v[20:23], v[28:31]
    s_waitcnt lgkmcnt(0)
    v_mfma_f32_16x16x32_bf16 v[28:31], v[36:39], v[20:23], v[28:31]
    s_nop 7
    s_setpc_b64 s[60:61]
Lbud_30:
    s_mov_b32 s74, 0
    s_branch H3_h0
Lbud_31:
    s_mov_b32 s74, 0
    s_branch ATT_h0
Lbud_32:
    s_mov_b32 s74, 0
    s_branch WO_sc
Lbud_33:
    s_mov_b32 s74, 0
    s_branch WO_go2
Lbud_34:
    s_mov_b32 s74, 0
    s_branch QP_go
Lbud_35:
    s_mov_b32 s74, 0
    s_branch QP_go
L_codeend:
    s_endpgm
    .fill 256, 4, 0xBF800000
.section .rodata,"a"
.p2align 6
.amdhsa_kernel interleave_layers__sliding_block_cached__sliding_block_cached__decode_kernel
  .amdhsa_next_free_vgpr 512
  .amdhsa_next_free_sgpr 102
  .amdhsa_accum_offset 256
  .amdhsa_group_segment_fixed_size 0
  .amdhsa_kernarg_size 104
  .amdhsa_user_sgpr_count 2
  .amdhsa_user_sgpr_kernarg_segment_ptr 1
  .amdhsa_system_sgpr_workgroup_id_x 1
  .amdhsa_float_denorm_mode_32 3
.end_amdhsa_kernel
.text
```
